```python
import torch

def _softmax(x, axis=-1):
    return torch.softmax(x, dim=axis)
def _gelu(x):
    return torch.nn.functional.gelu(x, approximate="tanh")
def _silu(x):
    return torch.nn.functional.silu(x)
def _sigmoid(x):
    return torch.sigmoid(x)
def _layernorm(x, axis=-1, eps=1e-5):
    m = x.mean(dim=axis, keepdim=True)
    v = x.var(dim=axis, keepdim=True, unbiased=False)
    return (x - m) / torch.sqrt(v + eps)
def _scatter_add(tgt, idx, src, axis=0):
    return tgt.clone().index_add_(axis, idx, src)
def _segment_sum(src, seg, n):
    out = torch.zeros((n,) + src.shape[1:], dtype=src.dtype)
    return out.index_add_(0, seg, src)
def _pad(x, pw):
    flat = tuple(v for pair in reversed(pw) for v in pair)
    return torch.nn.functional.pad(x, flat)

kernel_name = 'recurrent_scan__grouped_kv_mqa__swiglu_ffn__prompt'

def setup_inputs():

    _w = (lambda a: (lambda t: t.to(torch.bfloat16) if t.is_floating_point() else t)(torch.as_tensor(a)))
    def _A_setup():
        B, S, D, H = 1, 2048, 512, 32
        Dh = D // H
        return {
            "x": _w((lambda *s: torch.randn(*s, dtype=torch.bfloat16) * 0.05)(B, S, D)),
            "wq": _w((lambda *s: torch.randn(*s, dtype=torch.bfloat16) * 0.05)(D, H * Dh)),
            "wk": _w((lambda *s: torch.randn(*s, dtype=torch.bfloat16) * 0.05)(D, Dh)),
            "wv": _w((lambda *s: torch.randn(*s, dtype=torch.bfloat16) * 0.05)(D, Dh)),
            "wo": _w((lambda *s: torch.randn(*s, dtype=torch.bfloat16) * 0.05)(H * Dh, D)),
        }
    _A_in = _A_setup()

    def _B_setup():
        B, S, D, F = 1, 2048, 512, 1792
        return {
            "x": _w((lambda *s: torch.randn(*s, dtype=torch.bfloat16) * 0.05)(B, S, D)),
            "w_gate": _w((lambda *s: torch.randn(*s, dtype=torch.bfloat16) * 0.05)(D, F)),
            "w_up": _w((lambda *s: torch.randn(*s, dtype=torch.bfloat16) * 0.05)(D, F)),
            "w_down": _w((lambda *s: torch.randn(*s, dtype=torch.bfloat16) * 0.05)(F, D)),
        }
    _B_in = _B_setup()

    return {
        "A_x": _A_in["x"],
        "A_wq": _A_in["wq"],
        "A_wk": _A_in["wk"],
        "A_wv": _A_in["wv"],
        "A_wo": _A_in["wo"],
        "B_x": _B_in["x"],
        "B_w_gate": _B_in["w_gate"],
        "B_w_up": _B_in["w_up"],
        "B_w_down": _B_in["w_down"],
    }

def reference(A_x, A_wq, A_wk, A_wv, A_wo, B_x, B_w_gate, B_w_up, B_w_down):
    def _A_ref(x, wq, wk, wv, wo):
        B, S, D = x.shape
        H = 32
        Dh = D // H
        q = (lambda x, *d: x.permute(*d))((x @ wq).reshape(B, S, H, Dh), 0, 2, 1, 3)
        k = x @ wk
        v = x @ wv
        scores = torch.einsum("bhqd,bkd->bhqk", q, k) * (Dh ** -0.5)
        p = _softmax(scores, axis=-1)
        o = torch.einsum("bhqk,bkd->bhqd", p, v)
        return (lambda x, *d: x.permute(*d))(o, 0, 2, 1, 3).reshape(B, S, H * Dh) @ wo

    def _B_ref(x, w_gate, w_up, w_down):
        g = _silu(x @ w_gate)
        u = x @ w_up
        return (g * u) @ w_down

    x = A_x
    xn = _layernorm(x, axis=-1)
    s = _A_ref(xn, A_wq, A_wk, A_wv, A_wo)
    g = _silu(_B_ref(xn, B_w_gate, B_w_up, B_w_down))
    return x + s * g
```

```asm
; @launch grid=(256,1,1) block=(512,1,1) lds=163840
.amdgcn_target "amdgcn-amd-amdhsa--gfx950"
.text
.globl recurrent_scan__grouped_kv_mqa__swiglu_ffn__prompt_kernel
.p2align 8
.type recurrent_scan__grouped_kv_mqa__swiglu_ffn__prompt_kernel,@function
recurrent_scan__grouped_kv_mqa__swiglu_ffn__prompt_kernel:
    s_cmp_ge_u32 s2, 256
    s_cbranch_scc1 recurrent_scan__grouped_kv_mqa__swiglu_ffn__prompt_kernel_end
    s_load_dwordx16 s[48:63], s[0:1], 0
    s_load_dwordx8 s[64:71], s[0:1], 64
    s_and_b32 s83, s2, 7
    s_lshr_b32 s32, s2, 6
    s_lshl_b32 s32, s32, 3
    s_or_b32 s83, s83, s32
    s_lshr_b32 s84, s2, 3
    s_and_b32 s84, s84, 7
    s_and_b32 s29, s2, 3
    s_lshl_b32 s29, s29, 1
    s_lshr_b32 s32, s2, 3
    s_and_b32 s33, s32, 1
    s_or_b32 s29, s29, s33
    s_lshr_b32 s32, s32, 1
    s_lshr_b32 s28, s2, 2
    s_and_b32 s28, s28, 1
    s_lshl_b32 s28, s28, 4
    s_or_b32 s28, s28, s32
    v_lshrrev_b32 v2, 6, v0
    v_and_b32 v1, 63, v0
    s_nop 0
    v_readfirstlane_b32 s30, v2
    v_lshrrev_b32 v2, 3, v1
    v_and_b32 v3, 7, v1
    v_lshlrev_b32 v3, 4, v3
    s_lshl_b32 s32, s28, 6
    s_lshl_b32 s33, s30, 3
    s_add_u32 s32, s32, s33
    v_add_u32 v2, s32, v2
    v_lshlrev_b32 v2, 10, v2
    v_add_u32 v2, v2, v3
    s_and_b32 s31, s30, 3
    v_mov_b32 v3, 0
    v_mov_b32 v4, 0
    v_mov_b32 v5, 0
    v_mov_b32 v6, 0
    v_mov_b32 v7, 0
    v_mov_b32 v9, 0
    v_mov_b32 v10, 0
    v_mov_b32 v11, 0
    v_mov_b32 v12, 0
    v_mov_b32 v13, 0
    v_mov_b32 v14, 0
    v_mov_b32 v122, 0
    v_mov_b32 v123, 0
    s_waitcnt lgkmcnt(0)
    s_mov_b32 s4, s48
    s_mov_b32 s5, s49
    s_mov_b32 s6, 0x200000
    s_mov_b32 s7, 0x00020000
    buffer_load_dwordx4 v[8:11], v2, s[4:7], 0 offen offset:0
    buffer_load_dwordx4 v[12:15], v2, s[4:7], 0 offen offset:128
    buffer_load_dwordx4 v[16:19], v2, s[4:7], 0 offen offset:256
    buffer_load_dwordx4 v[20:23], v2, s[4:7], 0 offen offset:384
    buffer_load_dwordx4 v[24:27], v2, s[4:7], 0 offen offset:512
    buffer_load_dwordx4 v[28:31], v2, s[4:7], 0 offen offset:640
    buffer_load_dwordx4 v[32:35], v2, s[4:7], 0 offen offset:768
    buffer_load_dwordx4 v[36:39], v2, s[4:7], 0 offen offset:896
    s_mov_b32 s8, s70
    s_mov_b32 s9, s71
    s_mov_b32 s10, 0x10000000
    s_mov_b32 s11, 0x00020000
    s_mov_b32 s40, s68
    s_mov_b32 s41, s69
    s_mov_b32 s42, 0x100
    s_mov_b32 s43, 0x00020000
    s_cmp_lt_u32 s2, 8
    s_cbranch_scc0 L_nocas_3
    s_cmp_eq_u32 s30, 7
    s_cbranch_scc0 L_nocas_3
    s_memrealtime s[34:35]
    s_waitcnt lgkmcnt(0)
    s_or_b32 s34, s34, 1
    v_mov_b32 v122, s34
    v_mov_b32 v123, 0
    v_mov_b32 v124, 0
    s_mov_b64 exec, 1
    buffer_atomic_cmpswap v[122:123], v124, s[40:43], 0 offen sc1
    s_mov_b64 exec, -1
    s_nop 1
L_nocas_3:
    v_and_b32 v2, 31, v1
    v_lshlrev_b32 v2, 2, v2
    v_add_u32 v2, 106368, v2
    v_mov_b32 v3, 0
    ds_write_b32 v2, v3
    s_lshr_b32 s32, s30, 2
    s_mul_i32 s32, s32, 33792
    s_lshl_b32 s33, s31, 7
    s_add_u32 s32, s32, s33
    v_lshrrev_b32 v2, 3, v1
    v_lshlrev_b32 v2, 4, v2
    v_add_u32 v2, s32, v2
    v_bfe_u32 v3, v1, 1, 2
    v_mul_u32_u24 v3, 1056, v3
    v_add_u32 v2, v2, v3
    v_and_b32 v3, 1, v1
    v_mul_u32_u24 v3, 528, v3
    v_add_u32 v2, v2, v3
    s_cmp_ge_u32 s30, 4
    s_cbranch_scc1 L_p0g_2
    s_mov_b32 s16, s50
    s_mov_b32 s17, s51
    s_mov_b32 s18, 0x80000
    s_mov_b32 s19, 0x00020000
    s_mov_b32 s20, s50
    s_mov_b32 s21, s51
    s_mov_b32 s22, 0x80000
    s_mov_b32 s23, 0x00020000
    v_lshrrev_b32 v5, 3, v1
    v_bfe_u32 v6, v1, 4, 1
    v_lshlrev_b32 v6, 2, v6
    v_and_b32 v4, 7, v1
    v_xor_b32 v4, v4, v6
    v_lshlrev_b32 v4, 4, v4
    v_mul_u32_u24 v5, 1024, v5
    v_add_u32 v4, v4, v5
    s_lshl_b32 s32, s29, 7
    v_add_u32 v4, s32, v4
    s_lshl_b32 s32, s31, 16
    s_lshl_b32 s80, s31, 13
    s_add_u32 s80, s80, 67584
    s_add_u32 s72, s32, 0
    s_add_u32 s73, s32, 8192
    s_add_u32 s74, s32, 16384
    s_add_u32 s75, s32, 24576
    s_add_u32 s76, s32, 32768
    s_add_u32 s77, s32, 40960
    s_add_u32 s78, s32, 49152
    s_add_u32 s79, s32, 57344
    s_and_b32 s34, s31, 1
    v_bfe_u32 v5, v1, 2, 2
    v_lshrrev_b32 v6, 5, v1
    v_mul_u32_u24 v6, 8, v6
    v_add_u32 v6, v6, v5
    v_lshlrev_b32 v122, 7, v6
    v_lshrrev_b32 v5, 1, v5
    v_xor_b32 v5, s34, v5
    v_lshlrev_b32 v5, 6, v5
    v_add_u32 v122, v122, v5
    v_bfe_u32 v5, v1, 4, 1
    v_lshlrev_b32 v5, 5, v5
    v_add_u32 v122, v122, v5
    v_and_b32 v5, 3, v1
    v_lshlrev_b32 v5, 3, v5
    v_add_u32 v122, v122, v5
    v_add_u32 v122, 67584, v122
    v_lshrrev_b32 v5, 5, v1
    v_mul_u32_u24 v123, 528, v5
    v_and_b32 v5, 31, v1
    v_lshlrev_b32 v5, 4, v5
    v_add_u32 v123, v123, v5
    s_lshr_b32 s32, s31, 1
    s_mul_i32 s32, s32, 33792
    v_add_u32 v123, s32, v123
    s_branch L_xw_5
L_p0g_2:
    s_mul_i32 s39, s31, 14336
    s_add_u32 s39, s39, 106496
    s_cmp_eq_u32 s29, 7
    s_cbranch_scc1 L_p0g7_4
    s_mov_b32 s16, s60
    s_mov_b32 s17, s61
    s_mov_b32 s18, 0x1c0000
    s_mov_b32 s19, 0x00020000
    s_mov_b32 s20, s62
    s_mov_b32 s21, s63
    s_mov_b32 s22, 0x1c0000
    s_mov_b32 s23, 0x00020000
    v_lshrrev_b32 v5, 3, v1
    v_bfe_u32 v6, v1, 4, 1
    v_lshlrev_b32 v6, 2, v6
    v_and_b32 v4, 7, v1
    v_xor_b32 v4, v4, v6
    v_lshlrev_b32 v4, 4, v4
    v_mul_u32_u24 v5, 3584, v5
    v_add_u32 v4, v4, v5
    s_lshl_b32 s32, s29, 9
    s_lshl_b32 s33, s31, 7
    s_add_u32 s32, s32, s33
    v_add_u32 v4, s32, v4
    s_mov_b32 s80, s39
    s_mov_b32 s72, 0
    s_mov_b32 s73, 28672
    s_mov_b32 s74, 0
    s_mov_b32 s75, 28672
    s_mov_b32 s76, 57344
    s_mov_b32 s77, 86016
    s_mov_b32 s78, 57344
    s_mov_b32 s79, 86016
    v_bfe_u32 v3, v1, 2, 2
    v_lshrrev_b32 v123, 5, v1
    v_mul_u32_u24 v123, 8, v123
    v_add_u32 v123, v123, v3
    v_lshlrev_b32 v5, 7, v123
    v_lshrrev_b32 v3, 1, v3
    v_xor_b32 v3, 0, v3
    v_lshlrev_b32 v3, 6, v3
    v_add_u32 v5, v5, v3
    v_bfe_u32 v3, v1, 4, 1
    v_lshlrev_b32 v3, 5, v3
    v_add_u32 v5, v5, v3
    v_and_b32 v3, 3, v1
    v_lshlrev_b32 v3, 3, v3
    v_add_u32 v5, v5, v3
    v_bfe_u32 v3, v1, 2, 2
    v_lshrrev_b32 v123, 5, v1
    v_mul_u32_u24 v123, 8, v123
    v_add_u32 v123, v123, v3
    v_lshlrev_b32 v6, 7, v123
    v_lshrrev_b32 v3, 1, v3
    v_xor_b32 v3, 1, v3
    v_lshlrev_b32 v3, 6, v3
    v_add_u32 v6, v6, v3
    v_bfe_u32 v3, v1, 4, 1
    v_lshlrev_b32 v3, 5, v3
    v_add_u32 v6, v6, v3
    v_and_b32 v3, 3, v1
    v_lshlrev_b32 v3, 3, v3
    v_add_u32 v6, v6, v3
    v_add_u32 v5, s39, v5
    v_add_u32 v6, s39, v6
    v_lshrrev_b32 v3, 5, v1
    v_mul_u32_u24 v7, 528, v3
    v_and_b32 v3, 31, v1
    v_lshlrev_b32 v3, 4, v3
    v_add_u32 v7, v7, v3
    v_add_u32 v122, 33792, v7
    s_branch L_xw_5
L_p0g7_4:
    s_mov_b32 s16, s52
    s_mov_b32 s17, s53
    s_mov_b32 s18, 0x4000
    s_mov_b32 s19, 0x00020000
    s_mov_b32 s20, s54
    s_mov_b32 s21, s55
    s_mov_b32 s22, 0x4000
    s_mov_b32 s23, 0x00020000
    v_lshrrev_b32 v3, 1, v1
    v_and_b32 v5, 0x13, v3
    v_and_b32 v6, 4, v3
    v_lshlrev_b32 v6, 1, v6
    v_or_b32 v5, v5, v6
    v_and_b32 v6, 8, v3
    v_lshrrev_b32 v6, 1, v6
    v_or_b32 v5, v5, v6
    v_lshlrev_b32 v4, 5, v5
    v_and_b32 v3, 1, v1
    v_lshlrev_b32 v3, 4, v3
    v_add_u32 v4, v4, v3
    s_lshl_b32 s80, s31, 13
    s_add_u32 s80, s80, 106496
    s_lshl_b32 s32, s31, 12
    s_add_u32 s72, s32, 0
    s_add_u32 s73, s32, 1024
    s_add_u32 s74, s32, 0
    s_add_u32 s75, s32, 1024
    s_add_u32 s76, s32, 2048
    s_add_u32 s77, s32, 3072
    s_add_u32 s78, s32, 2048
    s_add_u32 s79, s32, 3072
    s_lshr_b32 s34, s31, 1
    s_and_b32 s35, s31, 1
    s_mul_i32 s32, s34, 33792
    s_lshl_b32 s33, s35, 8
    s_add_u32 s32, s32, s33
    v_lshrrev_b32 v3, 5, v1
    v_mul_u32_u24 v5, 1056, v3
    v_bfe_u32 v123, v1, 4, 1
    v_mul_u32_u24 v124, 528, v123
    v_add_u32 v5, v5, v124
    v_and_b32 v125, 15, v1
    v_lshlrev_b32 v125, 4, v125
    v_add_u32 v5, v5, v125
    v_add_u32 v5, s32, v5
    v_lshlrev_b32 v6, 9, v3
    v_lshlrev_b32 v124, 7, v123
    v_add_u32 v6, v6, v124
    v_bfe_u32 v124, v1, 2, 2
    v_lshlrev_b32 v124, 5, v124
    v_add_u32 v6, v6, v124
    v_and_b32 v124, 3, v1
    v_lshlrev_b32 v124, 3, v124
    v_add_u32 v6, v6, v124
    v_add_u32 v6, 106496, v6
    v_lshlrev_b32 v7, 9, v123
    v_add_u32 v7, v7, v125
    v_lshlrev_b32 v124, 3, v3
    v_add_u32 v7, v7, v124
    v_lshlrev_b32 v122, 8, v3
    v_add_u32 v122, v122, v125
    v_lshlrev_b32 v124, 3, v123
    v_add_u32 v122, v122, v124
    s_lshl_b32 s32, s28, 1
    s_add_u32 s32, s32, s34
    s_lshl_b32 s32, s32, 12
    s_add_u32 s32, s32, 4456448
    s_lshl_b32 s33, s35, 8
    s_add_u32 s81, s33, s32
    s_lshl_b32 s33, s35, 10
    s_add_u32 s82, s33, s32
    s_add_u32 s82, s82, 1024
L_xw_5:
    s_mov_b32 s89, 0
    s_cmp_lt_u32 s30, 4
    s_cbranch_scc1 L_e_7
    s_cmp_eq_u32 s29, 7
    s_cbranch_scc0 L_ne_6
L_e_7:
    s_add_u32 m0, s80, 0
    s_nop 0
    buffer_load_dwordx4 v4, s[16:19], s72 offen lds
    s_add_u32 m0, s80, 1024
    s_nop 0
    buffer_load_dwordx4 v4, s[16:19], s73 offen lds
    s_add_u32 m0, s80, 2048
    s_nop 0
    buffer_load_dwordx4 v4, s[20:23], s74 offen lds
    s_add_u32 m0, s80, 3072
    s_nop 0
    buffer_load_dwordx4 v4, s[20:23], s75 offen lds
    s_add_u32 m0, s80, 4096
    s_nop 0
    buffer_load_dwordx4 v4, s[16:19], s76 offen lds
    s_add_u32 m0, s80, 5120
    s_nop 0
    buffer_load_dwordx4 v4, s[16:19], s77 offen lds
    s_add_u32 m0, s80, 6144
    s_nop 0
    buffer_load_dwordx4 v4, s[20:23], s78 offen lds
    s_add_u32 m0, s80, 7168
    s_nop 0
    buffer_load_dwordx4 v4, s[20:23], s79 offen lds
L_ne_6:
    s_mov_b32 s47, 0xffff0000
    s_mov_b32 s85, 1
L_dry_ret:
    s_mov_b64 exec, -1
    s_mov_b64 vcc, -1
    s_mov_b32 s85, 0
    s_cmp_lt_u32 s30, 4
    s_cbranch_scc1 L_xw0_9
    s_cmp_eq_u32 s29, 7
    s_cbranch_scc1 L_xw0_9
    s_waitcnt vmcnt(0)
    s_cmp_eq_u32 s31, 0
    s_cbranch_scc0 L_pfw_11
    s_mov_b32 s12, s56
    s_mov_b32 s13, s57
    s_mov_b32 s14, 0x80000
    s_mov_b32 s15, 0x00020000
    s_mul_i32 s32, s2, 16
    v_min_u32 v125, 15, v1
    v_add_u32 v125, s32, v125
    v_lshlrev_b32 v125, 7, v125
    buffer_load_dword v120, v125, s[12:15], 0 offen
    buffer_load_dword v121, v125, s[12:15], 0 offen offset:64
L_pfw_11:
    s_cmp_eq_u32 s31, 3
    s_cbranch_scc0 L_pfw_12
    s_mov_b32 s12, s64
    s_mov_b32 s13, s65
    s_mov_b32 s14, 0x1c0000
    s_mov_b32 s15, 0x00020000
    s_mul_i32 s32, s2, 56
    v_min_u32 v125, 55, v1
    v_add_u32 v125, s32, v125
    v_lshlrev_b32 v125, 7, v125
    buffer_load_dword v120, v125, s[12:15], 0 offen
    buffer_load_dword v121, v125, s[12:15], 0 offen offset:64
L_pfw_12:
    s_cmp_eq_u32 s31, 1
    s_cbranch_scc0 L_pfw_13
    s_cmp_eq_u32 s29, 7
    s_cbranch_scc1 L_pfw_13
    s_mov_b32 s12, s60
    s_mov_b32 s13, s61
    s_mov_b32 s14, 0x1c0000
    s_mov_b32 s15, 0x00020000
    s_and_b32 s32, s28, 15
    s_mul_i32 s32, s32, 114688
    s_lshl_b32 s33, s29, 9
    s_add_u32 s32, s32, s33
    v_lshrrev_b32 v125, 2, v1
    v_mul_u32_u24 v125, 3584, v125
    v_and_b32 v124, 3, v1
    v_lshlrev_b32 v124, 7, v124
    v_add_u32 v125, v125, v124
    s_add_u32 s33, s32, 0
    buffer_load_dword v120, v125, s[12:15], s33 offen
    s_add_u32 s33, s32, 57344
    buffer_load_dword v121, v125, s[12:15], s33 offen
L_pfw_13:
    s_cmp_eq_u32 s31, 2
    s_cbranch_scc0 L_pfw_14
    s_cmp_eq_u32 s29, 7
    s_cbranch_scc1 L_pfw_14
    s_mov_b32 s12, s62
    s_mov_b32 s13, s63
    s_mov_b32 s14, 0x1c0000
    s_mov_b32 s15, 0x00020000
    s_and_b32 s32, s28, 15
    s_mul_i32 s32, s32, 114688
    s_lshl_b32 s33, s29, 9
    s_add_u32 s32, s32, s33
    v_lshrrev_b32 v125, 2, v1
    v_mul_u32_u24 v125, 3584, v125
    v_and_b32 v124, 3, v1
    v_lshlrev_b32 v124, 7, v124
    v_add_u32 v125, v125, v124
    s_add_u32 s33, s32, 0
    buffer_load_dword v120, v125, s[12:15], s33 offen
    s_add_u32 s33, s32, 57344
    buffer_load_dword v121, v125, s[12:15], s33 offen
L_pfw_14:
    s_mov_b64 vcc, 0
    s_branch L_xw1_10
L_xw0_9:
    s_waitcnt vmcnt(8)
    s_mov_b64 vcc, 0
    s_mov_b32 s89, 1
L_xw1_10:
L_lnbody_8:
    v_lshlrev_b32 v40, 16, v8
    v_and_b32 v41, s47, v8
    v_lshlrev_b32 v42, 16, v9
    v_and_b32 v43, s47, v9
    s_cbranch_vccz L_g_15
    s_add_u32 m0, s80, 0
    s_nop 0
    buffer_load_dwordx4 v4, s[16:19], s72 offen lds
L_g_15:
    v_lshlrev_b32 v44, 16, v10
    v_and_b32 v45, s47, v10
    v_lshlrev_b32 v46, 16, v11
    v_and_b32 v47, s47, v11
    v_lshlrev_b32 v48, 16, v12
    v_and_b32 v49, s47, v12
    v_lshlrev_b32 v50, 16, v13
    v_and_b32 v51, s47, v13
    v_lshlrev_b32 v52, 16, v14
    v_and_b32 v53, s47, v14
    v_lshlrev_b32 v54, 16, v15
    s_cbranch_vccz L_g_16
    s_add_u32 m0, s80, 1024
    s_nop 0
    buffer_load_dwordx4 v4, s[16:19], s73 offen lds
L_g_16:
    v_and_b32 v55, s47, v15
    v_lshlrev_b32 v56, 16, v16
    v_and_b32 v57, s47, v16
    v_lshlrev_b32 v58, 16, v17
    v_and_b32 v59, s47, v17
    v_lshlrev_b32 v60, 16, v18
    v_and_b32 v61, s47, v18
    v_lshlrev_b32 v62, 16, v19
    v_and_b32 v63, s47, v19
    v_lshlrev_b32 v64, 16, v20
    v_and_b32 v65, s47, v20
    s_cbranch_vccz L_g_17
    s_add_u32 m0, s80, 2048
    s_nop 0
    buffer_load_dwordx4 v4, s[20:23], s74 offen lds
L_g_17:
    v_lshlrev_b32 v66, 16, v21
    v_and_b32 v67, s47, v21
    v_lshlrev_b32 v68, 16, v22
    v_and_b32 v69, s47, v22
    v_lshlrev_b32 v70, 16, v23
    v_and_b32 v71, s47, v23
    v_lshlrev_b32 v72, 16, v24
    v_and_b32 v73, s47, v24
    v_lshlrev_b32 v74, 16, v25
    v_and_b32 v75, s47, v25
    v_lshlrev_b32 v76, 16, v26
    s_cbranch_vccz L_g_18
    s_add_u32 m0, s80, 3072
    s_nop 0
    buffer_load_dwordx4 v4, s[20:23], s75 offen lds
L_g_18:
    v_and_b32 v77, s47, v26
    v_lshlrev_b32 v78, 16, v27
    v_and_b32 v79, s47, v27
    v_lshlrev_b32 v80, 16, v28
    v_and_b32 v81, s47, v28
    v_lshlrev_b32 v82, 16, v29
    v_and_b32 v83, s47, v29
    v_lshlrev_b32 v84, 16, v30
    v_and_b32 v85, s47, v30
    v_lshlrev_b32 v86, 16, v31
    v_and_b32 v87, s47, v31
    s_cbranch_vccz L_g_19
    s_add_u32 m0, s80, 4096
    s_nop 0
    buffer_load_dwordx4 v4, s[16:19], s76 offen lds
L_g_19:
    v_lshlrev_b32 v88, 16, v32
    v_and_b32 v89, s47, v32
    v_lshlrev_b32 v90, 16, v33
    v_and_b32 v91, s47, v33
    v_lshlrev_b32 v92, 16, v34
    v_and_b32 v93, s47, v34
    v_lshlrev_b32 v94, 16, v35
    v_and_b32 v95, s47, v35
    v_lshlrev_b32 v96, 16, v36
    v_and_b32 v97, s47, v36
    v_lshlrev_b32 v98, 16, v37
    s_cbranch_vccz L_g_20
    s_add_u32 m0, s80, 5120
    s_nop 0
    buffer_load_dwordx4 v4, s[16:19], s77 offen lds
L_g_20:
    v_and_b32 v99, s47, v37
    v_lshlrev_b32 v100, 16, v38
    v_and_b32 v101, s47, v38
    v_lshlrev_b32 v102, 16, v39
    v_and_b32 v103, s47, v39
    v_pk_add_f32 v[104:105], v[40:41], v[48:49]
    v_pk_add_f32 v[106:107], v[42:43], v[50:51]
    v_pk_add_f32 v[108:109], v[44:45], v[52:53]
    v_pk_add_f32 v[110:111], v[46:47], v[54:55]
    v_pk_add_f32 v[104:105], v[104:105], v[56:57]
    v_pk_add_f32 v[106:107], v[106:107], v[58:59]
    s_cbranch_vccz L_g_21
    s_add_u32 m0, s80, 6144
    s_nop 0
    buffer_load_dwordx4 v4, s[20:23], s78 offen lds
L_g_21:
    v_pk_add_f32 v[108:109], v[108:109], v[60:61]
    v_pk_add_f32 v[110:111], v[110:111], v[62:63]
    v_pk_add_f32 v[104:105], v[104:105], v[64:65]
    v_pk_add_f32 v[106:107], v[106:107], v[66:67]
    v_pk_add_f32 v[108:109], v[108:109], v[68:69]
    v_pk_add_f32 v[110:111], v[110:111], v[70:71]
    v_pk_add_f32 v[104:105], v[104:105], v[72:73]
    v_pk_add_f32 v[106:107], v[106:107], v[74:75]
    v_pk_add_f32 v[108:109], v[108:109], v[76:77]
    v_pk_add_f32 v[110:111], v[110:111], v[78:79]
    v_pk_add_f32 v[104:105], v[104:105], v[80:81]
    s_cbranch_vccz L_g_22
    s_add_u32 m0, s80, 7168
    s_nop 0
    buffer_load_dwordx4 v4, s[20:23], s79 offen lds
L_g_22:
    v_pk_add_f32 v[106:107], v[106:107], v[82:83]
    v_pk_add_f32 v[108:109], v[108:109], v[84:85]
    v_pk_add_f32 v[110:111], v[110:111], v[86:87]
    v_pk_add_f32 v[104:105], v[104:105], v[88:89]
    v_pk_add_f32 v[106:107], v[106:107], v[90:91]
    v_pk_add_f32 v[108:109], v[108:109], v[92:93]
    v_pk_add_f32 v[110:111], v[110:111], v[94:95]
    v_pk_add_f32 v[104:105], v[104:105], v[96:97]
    v_pk_add_f32 v[106:107], v[106:107], v[98:99]
    v_pk_add_f32 v[108:109], v[108:109], v[100:101]
    v_pk_add_f32 v[110:111], v[110:111], v[102:103]
    v_pk_add_f32 v[104:105], v[104:105], v[106:107]
    v_pk_add_f32 v[108:109], v[108:109], v[110:111]
    v_pk_add_f32 v[104:105], v[104:105], v[108:109]
    v_add_f32 v104, v104, v105
    s_nop 1
    v_add_f32_dpp v104, v104, v104 quad_perm:[1,0,3,2] row_mask:0xf bank_mask:0xf
    s_nop 1
    v_add_f32_dpp v104, v104, v104 quad_perm:[2,3,0,1] row_mask:0xf bank_mask:0xf
    s_nop 1
    v_add_f32_dpp v104, v104, v104 row_half_mirror row_mask:0xf bank_mask:0xf
    v_mul_f32 v112, 0x3b000000, v104
    v_pk_add_f32 v[40:41], v[40:41], v[112:113] op_sel_hi:[1,0] neg_lo:[0,1] neg_hi:[0,1]
    v_pk_add_f32 v[42:43], v[42:43], v[112:113] op_sel_hi:[1,0] neg_lo:[0,1] neg_hi:[0,1]
    v_pk_add_f32 v[44:45], v[44:45], v[112:113] op_sel_hi:[1,0] neg_lo:[0,1] neg_hi:[0,1]
    v_pk_add_f32 v[46:47], v[46:47], v[112:113] op_sel_hi:[1,0] neg_lo:[0,1] neg_hi:[0,1]
    v_pk_add_f32 v[48:49], v[48:49], v[112:113] op_sel_hi:[1,0] neg_lo:[0,1] neg_hi:[0,1]
    v_pk_add_f32 v[50:51], v[50:51], v[112:113] op_sel_hi:[1,0] neg_lo:[0,1] neg_hi:[0,1]
    v_pk_add_f32 v[52:53], v[52:53], v[112:113] op_sel_hi:[1,0] neg_lo:[0,1] neg_hi:[0,1]
    v_pk_add_f32 v[54:55], v[54:55], v[112:113] op_sel_hi:[1,0] neg_lo:[0,1] neg_hi:[0,1]
    v_pk_add_f32 v[56:57], v[56:57], v[112:113] op_sel_hi:[1,0] neg_lo:[0,1] neg_hi:[0,1]
    v_pk_add_f32 v[58:59], v[58:59], v[112:113] op_sel_hi:[1,0] neg_lo:[0,1] neg_hi:[0,1]
    v_pk_add_f32 v[60:61], v[60:61], v[112:113] op_sel_hi:[1,0] neg_lo:[0,1] neg_hi:[0,1]
    v_pk_add_f32 v[62:63], v[62:63], v[112:113] op_sel_hi:[1,0] neg_lo:[0,1] neg_hi:[0,1]
    v_pk_add_f32 v[64:65], v[64:65], v[112:113] op_sel_hi:[1,0] neg_lo:[0,1] neg_hi:[0,1]
    v_pk_add_f32 v[66:67], v[66:67], v[112:113] op_sel_hi:[1,0] neg_lo:[0,1] neg_hi:[0,1]
    v_pk_add_f32 v[68:69], v[68:69], v[112:113] op_sel_hi:[1,0] neg_lo:[0,1] neg_hi:[0,1]
    v_pk_add_f32 v[70:71], v[70:71], v[112:113] op_sel_hi:[1,0] neg_lo:[0,1] neg_hi:[0,1]
    v_pk_add_f32 v[72:73], v[72:73], v[112:113] op_sel_hi:[1,0] neg_lo:[0,1] neg_hi:[0,1]
    v_pk_add_f32 v[74:75], v[74:75], v[112:113] op_sel_hi:[1,0] neg_lo:[0,1] neg_hi:[0,1]
    v_pk_add_f32 v[76:77], v[76:77], v[112:113] op_sel_hi:[1,0] neg_lo:[0,1] neg_hi:[0,1]
    v_pk_add_f32 v[78:79], v[78:79], v[112:113] op_sel_hi:[1,0] neg_lo:[0,1] neg_hi:[0,1]
    v_pk_add_f32 v[80:81], v[80:81], v[112:113] op_sel_hi:[1,0] neg_lo:[0,1] neg_hi:[0,1]
    v_pk_add_f32 v[82:83], v[82:83], v[112:113] op_sel_hi:[1,0] neg_lo:[0,1] neg_hi:[0,1]
    v_pk_add_f32 v[84:85], v[84:85], v[112:113] op_sel_hi:[1,0] neg_lo:[0,1] neg_hi:[0,1]
    v_pk_add_f32 v[86:87], v[86:87], v[112:113] op_sel_hi:[1,0] neg_lo:[0,1] neg_hi:[0,1]
    v_pk_add_f32 v[88:89], v[88:89], v[112:113] op_sel_hi:[1,0] neg_lo:[0,1] neg_hi:[0,1]
    v_pk_add_f32 v[90:91], v[90:91], v[112:113] op_sel_hi:[1,0] neg_lo:[0,1] neg_hi:[0,1]
    v_pk_add_f32 v[92:93], v[92:93], v[112:113] op_sel_hi:[1,0] neg_lo:[0,1] neg_hi:[0,1]
    v_pk_add_f32 v[94:95], v[94:95], v[112:113] op_sel_hi:[1,0] neg_lo:[0,1] neg_hi:[0,1]
    v_pk_add_f32 v[96:97], v[96:97], v[112:113] op_sel_hi:[1,0] neg_lo:[0,1] neg_hi:[0,1]
    v_pk_add_f32 v[98:99], v[98:99], v[112:113] op_sel_hi:[1,0] neg_lo:[0,1] neg_hi:[0,1]
    v_pk_add_f32 v[100:101], v[100:101], v[112:113] op_sel_hi:[1,0] neg_lo:[0,1] neg_hi:[0,1]
    v_pk_add_f32 v[102:103], v[102:103], v[112:113] op_sel_hi:[1,0] neg_lo:[0,1] neg_hi:[0,1]
    v_pk_mul_f32 v[104:105], v[40:41], v[40:41]
    v_pk_mul_f32 v[106:107], v[42:43], v[42:43]
    v_pk_mul_f32 v[108:109], v[44:45], v[44:45]
    v_pk_mul_f32 v[110:111], v[46:47], v[46:47]
    v_pk_fma_f32 v[104:105], v[48:49], v[48:49], v[104:105]
    v_pk_fma_f32 v[106:107], v[50:51], v[50:51], v[106:107]
    v_pk_fma_f32 v[108:109], v[52:53], v[52:53], v[108:109]
    v_pk_fma_f32 v[110:111], v[54:55], v[54:55], v[110:111]
    v_pk_fma_f32 v[104:105], v[56:57], v[56:57], v[104:105]
    v_pk_fma_f32 v[106:107], v[58:59], v[58:59], v[106:107]
    v_pk_fma_f32 v[108:109], v[60:61], v[60:61], v[108:109]
    v_pk_fma_f32 v[110:111], v[62:63], v[62:63], v[110:111]
    v_pk_fma_f32 v[104:105], v[64:65], v[64:65], v[104:105]
    v_pk_fma_f32 v[106:107], v[66:67], v[66:67], v[106:107]
    v_pk_fma_f32 v[108:109], v[68:69], v[68:69], v[108:109]
    v_pk_fma_f32 v[110:111], v[70:71], v[70:71], v[110:111]
    v_pk_fma_f32 v[104:105], v[72:73], v[72:73], v[104:105]
    v_pk_fma_f32 v[106:107], v[74:75], v[74:75], v[106:107]
    v_pk_fma_f32 v[108:109], v[76:77], v[76:77], v[108:109]
    v_pk_fma_f32 v[110:111], v[78:79], v[78:79], v[110:111]
    v_pk_fma_f32 v[104:105], v[80:81], v[80:81], v[104:105]
    v_pk_fma_f32 v[106:107], v[82:83], v[82:83], v[106:107]
    v_pk_fma_f32 v[108:109], v[84:85], v[84:85], v[108:109]
    v_pk_fma_f32 v[110:111], v[86:87], v[86:87], v[110:111]
    v_pk_fma_f32 v[104:105], v[88:89], v[88:89], v[104:105]
    v_pk_fma_f32 v[106:107], v[90:91], v[90:91], v[106:107]
    v_pk_fma_f32 v[108:109], v[92:93], v[92:93], v[108:109]
    v_pk_fma_f32 v[110:111], v[94:95], v[94:95], v[110:111]
    v_pk_fma_f32 v[104:105], v[96:97], v[96:97], v[104:105]
    v_pk_fma_f32 v[106:107], v[98:99], v[98:99], v[106:107]
    v_pk_fma_f32 v[108:109], v[100:101], v[100:101], v[108:109]
    v_pk_fma_f32 v[110:111], v[102:103], v[102:103], v[110:111]
    v_pk_add_f32 v[104:105], v[104:105], v[106:107]
    v_pk_add_f32 v[108:109], v[108:109], v[110:111]
    v_pk_add_f32 v[104:105], v[104:105], v[108:109]
    v_add_f32 v104, v104, v105
    s_nop 1
    v_add_f32_dpp v104, v104, v104 quad_perm:[1,0,3,2] row_mask:0xf bank_mask:0xf
    s_nop 1
    v_add_f32_dpp v104, v104, v104 quad_perm:[2,3,0,1] row_mask:0xf bank_mask:0xf
    s_nop 1
    v_add_f32_dpp v104, v104, v104 row_half_mirror row_mask:0xf bank_mask:0xf
    v_mul_f32 v114, 0x3b000000, v104
    v_cvt_pk_bf16_f32 v114, v114, v114
    v_lshlrev_b32 v114, 16, v114
    v_add_f32 v114, 0x3727c5ac, v114
    v_cvt_pk_bf16_f32 v114, v114, v114
    v_lshlrev_b32 v114, 16, v114
    v_sqrt_f32 v114, v114
    s_nop 0
    v_cvt_pk_bf16_f32 v114, v114, v114
    v_lshlrev_b32 v114, 16, v114
    v_rcp_f32 v116, v114
    v_mov_b32 v118, v112
    v_cvt_pk_bf16_f32 v118, v118, v118
    v_lshlrev_b32 v118, 16, v118
    v_sub_f32 v118, v112, v118
    v_mul_f32 v118, v118, v116
    v_pk_fma_f32 v[40:41], v[40:41], v[116:117], v[118:119] op_sel_hi:[1,0,0]
    v_pk_fma_f32 v[42:43], v[42:43], v[116:117], v[118:119] op_sel_hi:[1,0,0]
    v_pk_fma_f32 v[44:45], v[44:45], v[116:117], v[118:119] op_sel_hi:[1,0,0]
    v_pk_fma_f32 v[46:47], v[46:47], v[116:117], v[118:119] op_sel_hi:[1,0,0]
    v_cvt_pk_bf16_f32 v8, v40, v41
    v_cvt_pk_bf16_f32 v9, v42, v43
    v_cvt_pk_bf16_f32 v10, v44, v45
    v_cvt_pk_bf16_f32 v11, v46, v47
    ds_write_b128 v2, v[8:11] offset:0
    v_pk_fma_f32 v[48:49], v[48:49], v[116:117], v[118:119] op_sel_hi:[1,0,0]
    v_pk_fma_f32 v[50:51], v[50:51], v[116:117], v[118:119] op_sel_hi:[1,0,0]
    v_pk_fma_f32 v[52:53], v[52:53], v[116:117], v[118:119] op_sel_hi:[1,0,0]
    v_pk_fma_f32 v[54:55], v[54:55], v[116:117], v[118:119] op_sel_hi:[1,0,0]
    v_cvt_pk_bf16_f32 v12, v48, v49
    v_cvt_pk_bf16_f32 v13, v50, v51
    v_cvt_pk_bf16_f32 v14, v52, v53
    v_cvt_pk_bf16_f32 v15, v54, v55
    ds_write_b128 v2, v[12:15] offset:4224
    v_pk_fma_f32 v[56:57], v[56:57], v[116:117], v[118:119] op_sel_hi:[1,0,0]
    v_pk_fma_f32 v[58:59], v[58:59], v[116:117], v[118:119] op_sel_hi:[1,0,0]
    v_pk_fma_f32 v[60:61], v[60:61], v[116:117], v[118:119] op_sel_hi:[1,0,0]
    v_pk_fma_f32 v[62:63], v[62:63], v[116:117], v[118:119] op_sel_hi:[1,0,0]
    v_cvt_pk_bf16_f32 v16, v56, v57
    v_cvt_pk_bf16_f32 v17, v58, v59
    v_cvt_pk_bf16_f32 v18, v60, v61
    v_cvt_pk_bf16_f32 v19, v62, v63
    ds_write_b128 v2, v[16:19] offset:8448
    v_pk_fma_f32 v[64:65], v[64:65], v[116:117], v[118:119] op_sel_hi:[1,0,0]
    v_pk_fma_f32 v[66:67], v[66:67], v[116:117], v[118:119] op_sel_hi:[1,0,0]
    v_pk_fma_f32 v[68:69], v[68:69], v[116:117], v[118:119] op_sel_hi:[1,0,0]
    v_pk_fma_f32 v[70:71], v[70:71], v[116:117], v[118:119] op_sel_hi:[1,0,0]
    v_cvt_pk_bf16_f32 v20, v64, v65
    v_cvt_pk_bf16_f32 v21, v66, v67
    v_cvt_pk_bf16_f32 v22, v68, v69
    v_cvt_pk_bf16_f32 v23, v70, v71
    ds_write_b128 v2, v[20:23] offset:12672
    v_pk_fma_f32 v[72:73], v[72:73], v[116:117], v[118:119] op_sel_hi:[1,0,0]
    v_pk_fma_f32 v[74:75], v[74:75], v[116:117], v[118:119] op_sel_hi:[1,0,0]
    v_pk_fma_f32 v[76:77], v[76:77], v[116:117], v[118:119] op_sel_hi:[1,0,0]
    v_pk_fma_f32 v[78:79], v[78:79], v[116:117], v[118:119] op_sel_hi:[1,0,0]
    v_cvt_pk_bf16_f32 v24, v72, v73
    v_cvt_pk_bf16_f32 v25, v74, v75
    v_cvt_pk_bf16_f32 v26, v76, v77
    v_cvt_pk_bf16_f32 v27, v78, v79
    ds_write_b128 v2, v[24:27] offset:16896
    v_pk_fma_f32 v[80:81], v[80:81], v[116:117], v[118:119] op_sel_hi:[1,0,0]
    v_pk_fma_f32 v[82:83], v[82:83], v[116:117], v[118:119] op_sel_hi:[1,0,0]
    v_pk_fma_f32 v[84:85], v[84:85], v[116:117], v[118:119] op_sel_hi:[1,0,0]
    v_pk_fma_f32 v[86:87], v[86:87], v[116:117], v[118:119] op_sel_hi:[1,0,0]
    v_cvt_pk_bf16_f32 v28, v80, v81
    v_cvt_pk_bf16_f32 v29, v82, v83
    v_cvt_pk_bf16_f32 v30, v84, v85
    v_cvt_pk_bf16_f32 v31, v86, v87
    ds_write_b128 v2, v[28:31] offset:21120
    v_pk_fma_f32 v[88:89], v[88:89], v[116:117], v[118:119] op_sel_hi:[1,0,0]
    v_pk_fma_f32 v[90:91], v[90:91], v[116:117], v[118:119] op_sel_hi:[1,0,0]
    v_pk_fma_f32 v[92:93], v[92:93], v[116:117], v[118:119] op_sel_hi:[1,0,0]
    v_pk_fma_f32 v[94:95], v[94:95], v[116:117], v[118:119] op_sel_hi:[1,0,0]
    v_cvt_pk_bf16_f32 v32, v88, v89
    v_cvt_pk_bf16_f32 v33, v90, v91
    v_cvt_pk_bf16_f32 v34, v92, v93
    v_cvt_pk_bf16_f32 v35, v94, v95
    ds_write_b128 v2, v[32:35] offset:25344
    v_pk_fma_f32 v[96:97], v[96:97], v[116:117], v[118:119] op_sel_hi:[1,0,0]
    v_pk_fma_f32 v[98:99], v[98:99], v[116:117], v[118:119] op_sel_hi:[1,0,0]
    v_pk_fma_f32 v[100:101], v[100:101], v[116:117], v[118:119] op_sel_hi:[1,0,0]
    v_pk_fma_f32 v[102:103], v[102:103], v[116:117], v[118:119] op_sel_hi:[1,0,0]
    v_cvt_pk_bf16_f32 v36, v96, v97
    v_cvt_pk_bf16_f32 v37, v98, v99
    v_cvt_pk_bf16_f32 v38, v100, v101
    v_cvt_pk_bf16_f32 v39, v102, v103
    ds_write_b128 v2, v[36:39] offset:29568
    s_cmp_eq_u32 s85, 1
    s_cbranch_scc1 L_dry_ret
    s_cmp_lt_u32 s30, 4
    s_cbranch_scc1 L_w1_23
    s_cmp_eq_u32 s29, 7
    s_cbranch_scc1 L_w1_23
    s_branch L_w2_24
L_w1_23:
    s_waitcnt vmcnt(0)
L_w2_24:
    s_waitcnt lgkmcnt(0)
    s_barrier
    s_cmp_ge_u32 s30, 4
    s_cbranch_scc1 L_roleg_26
    s_setprio 1
    s_lshr_b32 s46, s31, 1
    s_and_b32 s47, s31, 1
    s_lshl_b32 s44, s46, 2
    s_cmp_eq_u32 s31, 0
    s_cbranch_scc0 L_n0_27
    v_mov_b32 v5, 0
    buffer_load_dword v192, v5, s[40:43], 0 offen sc1
L_n0_27:
L_dry_q:
    ds_read_b64_tr_b16 v[56:57], v122 offset:0
    ds_read_b64_tr_b16 v[58:59], v122 offset:512
    ds_read_b128 v[72:75], v123 offset:0
    ds_read_b64_tr_b16 v[60:61], v122 offset:2048
    ds_read_b64_tr_b16 v[62:63], v122 offset:2560
    ds_read_b128 v[76:79], v123 offset:1056
    ds_read_b64_tr_b16 v[64:65], v122 offset:4096
    ds_read_b64_tr_b16 v[66:67], v122 offset:4608
    ds_read_b128 v[80:83], v123 offset:2112
    ds_read_b64_tr_b16 v[68:69], v122 offset:6144
    ds_read_b64_tr_b16 v[70:71], v122 offset:6656
    ds_read_b128 v[84:87], v123 offset:3168
    s_waitcnt lgkmcnt(9)
    v_mfma_f32_32x32x16_bf16 v[40:55], v[56:59], v[72:75], 0
    ds_read_b64_tr_b16 v[56:57], v122 offset:8192
    ds_read_b64_tr_b16 v[58:59], v122 offset:8704
    ds_read_b128 v[72:75], v123 offset:4224
    s_waitcnt lgkmcnt(9)
    v_mfma_f32_32x32x16_bf16 v[40:55], v[60:63], v[76:79], v[40:55]
    ds_read_b64_tr_b16 v[60:61], v122 offset:10240
    ds_read_b64_tr_b16 v[62:63], v122 offset:10752
    ds_read_b128 v[76:79], v123 offset:5280
    s_waitcnt lgkmcnt(9)
    v_mfma_f32_32x32x16_bf16 v[40:55], v[64:67], v[80:83], v[40:55]
    ds_read_b64_tr_b16 v[64:65], v122 offset:12288
    ds_read_b64_tr_b16 v[66:67], v122 offset:12800
    ds_read_b128 v[80:83], v123 offset:6336
    s_waitcnt lgkmcnt(9)
    v_mfma_f32_32x32x16_bf16 v[40:55], v[68:71], v[84:87], v[40:55]
    ds_read_b64_tr_b16 v[68:69], v122 offset:14336
    ds_read_b64_tr_b16 v[70:71], v122 offset:14848
    ds_read_b128 v[84:87], v123 offset:7392
    s_waitcnt lgkmcnt(9)
    v_mfma_f32_32x32x16_bf16 v[40:55], v[56:59], v[72:75], v[40:55]
    ds_read_b64_tr_b16 v[56:57], v122 offset:16384
    ds_read_b64_tr_b16 v[58:59], v122 offset:16896
    ds_read_b128 v[72:75], v123 offset:8448
    s_waitcnt lgkmcnt(9)
    v_mfma_f32_32x32x16_bf16 v[40:55], v[60:63], v[76:79], v[40:55]
    ds_read_b64_tr_b16 v[60:61], v122 offset:18432
    ds_read_b64_tr_b16 v[62:63], v122 offset:18944
    ds_read_b128 v[76:79], v123 offset:9504
    s_waitcnt lgkmcnt(9)
    v_mfma_f32_32x32x16_bf16 v[40:55], v[64:67], v[80:83], v[40:55]
    ds_read_b64_tr_b16 v[64:65], v122 offset:20480
    ds_read_b64_tr_b16 v[66:67], v122 offset:20992
    ds_read_b128 v[80:83], v123 offset:10560
    s_waitcnt lgkmcnt(9)
    v_mfma_f32_32x32x16_bf16 v[40:55], v[68:71], v[84:87], v[40:55]
    ds_read_b64_tr_b16 v[68:69], v122 offset:22528
    ds_read_b64_tr_b16 v[70:71], v122 offset:23040
    ds_read_b128 v[84:87], v123 offset:11616
    s_waitcnt lgkmcnt(9)
    v_mfma_f32_32x32x16_bf16 v[40:55], v[56:59], v[72:75], v[40:55]
    ds_read_b64_tr_b16 v[56:57], v122 offset:24576
    ds_read_b64_tr_b16 v[58:59], v122 offset:25088
    ds_read_b128 v[72:75], v123 offset:12672
    s_waitcnt lgkmcnt(9)
    v_mfma_f32_32x32x16_bf16 v[40:55], v[60:63], v[76:79], v[40:55]
    ds_read_b64_tr_b16 v[60:61], v122 offset:26624
    ds_read_b64_tr_b16 v[62:63], v122 offset:27136
    ds_read_b128 v[76:79], v123 offset:13728
    s_waitcnt lgkmcnt(9)
    v_mfma_f32_32x32x16_bf16 v[40:55], v[64:67], v[80:83], v[40:55]
    ds_read_b64_tr_b16 v[64:65], v122 offset:28672
    ds_read_b64_tr_b16 v[66:67], v122 offset:29184
    ds_read_b128 v[80:83], v123 offset:14784
    s_waitcnt lgkmcnt(9)
    v_mfma_f32_32x32x16_bf16 v[40:55], v[68:71], v[84:87], v[40:55]
    ds_read_b64_tr_b16 v[68:69], v122 offset:30720
    ds_read_b64_tr_b16 v[70:71], v122 offset:31232
    ds_read_b128 v[84:87], v123 offset:15840
    s_waitcnt lgkmcnt(9)
    v_mfma_f32_32x32x16_bf16 v[40:55], v[56:59], v[72:75], v[40:55]
    s_waitcnt lgkmcnt(6)
    v_mfma_f32_32x32x16_bf16 v[40:55], v[60:63], v[76:79], v[40:55]
    s_waitcnt lgkmcnt(3)
    v_mfma_f32_32x32x16_bf16 v[40:55], v[64:67], v[80:83], v[40:55]
    s_waitcnt lgkmcnt(0)
    v_mfma_f32_32x32x16_bf16 v[40:55], v[68:71], v[84:87], v[40:55]
    s_cmp_eq_u32 s85, 1
    s_cbranch_scc1 L_q16_28
    v_mov_b32 v5, 106372
    v_mov_b32 v6, 1
    s_mov_b64 exec, 1
    ds_add_u32 v5, v6
    s_mov_b64 exec, -1
    s_lshl_b32 s35, s31, 16
    s_add_u32 s35, s35, 262144
    v_mov_b32 v5, 106372
    s_mov_b32 s37, 65536
L_ldsw_29:
    ds_read_b32 v6, v5
    s_waitcnt lgkmcnt(0)
    v_readfirstlane_b32 s32, v6
    s_nop 3
    s_cmp_ge_u32 s32, 4
    s_cbranch_scc1 L_ldsd_30
    s_sub_u32 s37, s37, 1
    s_cmp_eq_u32 s37, 0
    s_cbranch_scc1 recurrent_scan__grouped_kv_mqa__swiglu_ffn__prompt_kernel_end
    s_sleep 1
    s_branch L_ldsw_29
L_ldsd_30:
    s_add_u32 m0, s80, 0
    s_add_u32 s33, s35, 0
    buffer_load_dwordx4 v4, s[16:19], s33 offen lds
    s_add_u32 m0, s80, 1024
    s_add_u32 s33, s35, 8192
    buffer_load_dwordx4 v4, s[16:19], s33 offen lds
    s_add_u32 m0, s80, 2048
    s_add_u32 s33, s35, 16384
    buffer_load_dwordx4 v4, s[16:19], s33 offen lds
    s_add_u32 m0, s80, 3072
    s_add_u32 s33, s35, 24576
    buffer_load_dwordx4 v4, s[16:19], s33 offen lds
    s_add_u32 m0, s80, 4096
    s_add_u32 s33, s35, 32768
    buffer_load_dwordx4 v4, s[16:19], s33 offen lds
    s_add_u32 m0, s80, 5120
    s_add_u32 s33, s35, 40960
    buffer_load_dwordx4 v4, s[16:19], s33 offen lds
    s_add_u32 m0, s80, 6144
    s_add_u32 s33, s35, 49152
    buffer_load_dwordx4 v4, s[16:19], s33 offen lds
    s_add_u32 m0, s80, 7168
    s_add_u32 s33, s35, 57344
    buffer_load_dwordx4 v4, s[16:19], s33 offen lds
    v_lshlrev_b32 v2, 4, v1
    v_mov_b32 v8, 0xdddddddd
    s_lshl_b32 s32, s47, 17
    s_add_u32 s32, s32, 4456448
    v_add_u32 v9, s32, v2
    v_lshrrev_b32 v5, 5, v1
    v_lshlrev_b32 v3, 8, v5
    v_and_b32 v5, 15, v1
    v_lshlrev_b32 v6, 4, v5
    v_add_u32 v3, v3, v6
    v_and_b32 v5, 11, v5
    v_cmp_eq_u32 vcc, 0, v5
    v_mov_b32 v6, 528
    v_mov_b32 v7, 512
    v_cndmask_b32 v6, v6, v7, vcc
    v_bfe_u32 v5, v1, 4, 1
    v_cmp_eq_u32 vcc, 1, v5
    s_nop 1
    v_cndmask_b32 v3, v3, v6, vcc
    v_add_u32 v3, s32, v3
    s_mul_i32 s33, s31, 4608
    s_add_u32 s33, s33, 75776
    v_add_u32 v10, s33, v2
    v_lshlrev_b32 v7, 2, v1
    v_add_u32 v11, s33, v7
    s_xor_b32 s33, s31, 1
    s_mul_i32 s33, s33, 4608
    s_add_u32 s33, s33, 75776
    v_add_u32 v12, s33, v2
    v_add_u32 v13, s33, v7
    s_waitcnt vmcnt(0)
    s_cmp_eq_u32 s31, 0
    s_cbranch_scc0 L_n1_31
    v_readfirstlane_b32 s38, v192
    s_nop 3
    s_cmp_lg_u32 s38, 0
    s_cbranch_scc1 L_n2_32
    s_mov_b32 s37, 65536
L_nf_33:
    v_mov_b32 v5, 0
    buffer_load_dword v6, v5, s[40:43], 0 offen sc1
    s_waitcnt vmcnt(0)
    v_readfirstlane_b32 s38, v6
    s_nop 3
    s_cmp_lg_u32 s38, 0
    s_cbranch_scc1 L_nfd_34
    s_sub_u32 s37, s37, 1
    s_cmp_eq_u32 s37, 0
    s_cbranch_scc1 recurrent_scan__grouped_kv_mqa__swiglu_ffn__prompt_kernel_end
    s_sleep 2
    s_branch L_nf_33
L_nfd_34:
L_n2_32:
    v_mov_b32 v5, 106368
    v_mov_b32 v6, s38
    ds_write_b32 v5, v6
L_n1_31:
    v_mov_b32 v5, 106376
    v_mov_b32 v6, 1
    s_mov_b64 exec, 1
    ds_add_u32 v5, v6
    s_mov_b64 exec, -1
    v_mov_b32 v5, 106376
    s_mov_b32 s37, 65536
L_ldsw_35:
    ds_read_b32 v6, v5
    s_waitcnt lgkmcnt(0)
    v_readfirstlane_b32 s32, v6
    s_nop 3
    s_cmp_ge_u32 s32, 4
    s_cbranch_scc1 L_ldsd_36
    s_sub_u32 s37, s37, 1
    s_cmp_eq_u32 s37, 0
    s_cbranch_scc1 recurrent_scan__grouped_kv_mqa__swiglu_ffn__prompt_kernel_end
    s_sleep 1
    s_branch L_ldsw_35
L_ldsd_36:
L_q16_28:
    ds_read_b64_tr_b16 v[56:57], v122 offset:0
    ds_read_b64_tr_b16 v[58:59], v122 offset:512
    ds_read_b128 v[72:75], v123 offset:16896
    ds_read_b64_tr_b16 v[60:61], v122 offset:2048
    ds_read_b64_tr_b16 v[62:63], v122 offset:2560
    ds_read_b128 v[76:79], v123 offset:17952
    ds_read_b64_tr_b16 v[64:65], v122 offset:4096
    ds_read_b64_tr_b16 v[66:67], v122 offset:4608
    ds_read_b128 v[80:83], v123 offset:19008
    ds_read_b64_tr_b16 v[68:69], v122 offset:6144
    ds_read_b64_tr_b16 v[70:71], v122 offset:6656
    ds_read_b128 v[84:87], v123 offset:20064
    s_waitcnt lgkmcnt(9)
    v_mfma_f32_32x32x16_bf16 v[40:55], v[56:59], v[72:75], v[40:55]
    ds_read_b64_tr_b16 v[56:57], v122 offset:8192
    ds_read_b64_tr_b16 v[58:59], v122 offset:8704
    ds_read_b128 v[72:75], v123 offset:21120
    s_waitcnt lgkmcnt(9)
    v_mfma_f32_32x32x16_bf16 v[40:55], v[60:63], v[76:79], v[40:55]
    ds_read_b64_tr_b16 v[60:61], v122 offset:10240
    ds_read_b64_tr_b16 v[62:63], v122 offset:10752
    ds_read_b128 v[76:79], v123 offset:22176
    s_waitcnt lgkmcnt(9)
    v_mfma_f32_32x32x16_bf16 v[40:55], v[64:67], v[80:83], v[40:55]
    ds_read_b64_tr_b16 v[64:65], v122 offset:12288
    ds_read_b64_tr_b16 v[66:67], v122 offset:12800
    ds_read_b128 v[80:83], v123 offset:23232
    s_waitcnt lgkmcnt(9)
    v_mfma_f32_32x32x16_bf16 v[40:55], v[68:71], v[84:87], v[40:55]
    ds_read_b64_tr_b16 v[68:69], v122 offset:14336
    ds_read_b64_tr_b16 v[70:71], v122 offset:14848
    ds_read_b128 v[84:87], v123 offset:24288
    s_waitcnt lgkmcnt(9)
    v_mfma_f32_32x32x16_bf16 v[40:55], v[56:59], v[72:75], v[40:55]
    ds_read_b64_tr_b16 v[56:57], v122 offset:16384
    ds_read_b64_tr_b16 v[58:59], v122 offset:16896
    ds_read_b128 v[72:75], v123 offset:25344
    s_waitcnt lgkmcnt(9)
    v_mfma_f32_32x32x16_bf16 v[40:55], v[60:63], v[76:79], v[40:55]
    ds_read_b64_tr_b16 v[60:61], v122 offset:18432
    ds_read_b64_tr_b16 v[62:63], v122 offset:18944
    ds_read_b128 v[76:79], v123 offset:26400
    s_waitcnt lgkmcnt(9)
    v_mfma_f32_32x32x16_bf16 v[40:55], v[64:67], v[80:83], v[40:55]
    ds_read_b64_tr_b16 v[64:65], v122 offset:20480
    ds_read_b64_tr_b16 v[66:67], v122 offset:20992
    ds_read_b128 v[80:83], v123 offset:27456
    s_waitcnt lgkmcnt(9)
    v_mfma_f32_32x32x16_bf16 v[40:55], v[68:71], v[84:87], v[40:55]
    ds_read_b64_tr_b16 v[68:69], v122 offset:22528
    ds_read_b64_tr_b16 v[70:71], v122 offset:23040
    ds_read_b128 v[84:87], v123 offset:28512
    s_waitcnt lgkmcnt(9)
    v_mfma_f32_32x32x16_bf16 v[40:55], v[56:59], v[72:75], v[40:55]
    ds_read_b64_tr_b16 v[56:57], v122 offset:24576
    ds_read_b64_tr_b16 v[58:59], v122 offset:25088
    ds_read_b128 v[72:75], v123 offset:29568
    s_waitcnt lgkmcnt(9)
    v_mfma_f32_32x32x16_bf16 v[40:55], v[60:63], v[76:79], v[40:55]
    ds_read_b64_tr_b16 v[60:61], v122 offset:26624
    ds_read_b64_tr_b16 v[62:63], v122 offset:27136
    ds_read_b128 v[76:79], v123 offset:30624
    s_waitcnt lgkmcnt(9)
    v_mfma_f32_32x32x16_bf16 v[40:55], v[64:67], v[80:83], v[40:55]
    ds_read_b64_tr_b16 v[64:65], v122 offset:28672
    ds_read_b64_tr_b16 v[66:67], v122 offset:29184
    ds_read_b128 v[80:83], v123 offset:31680
    s_waitcnt lgkmcnt(9)
    v_mfma_f32_32x32x16_bf16 v[40:55], v[68:71], v[84:87], v[40:55]
    ds_read_b64_tr_b16 v[68:69], v122 offset:30720
    ds_read_b64_tr_b16 v[70:71], v122 offset:31232
    ds_read_b128 v[84:87], v123 offset:32736
    s_waitcnt lgkmcnt(9)
    v_mfma_f32_32x32x16_bf16 v[40:55], v[56:59], v[72:75], v[40:55]
    s_waitcnt lgkmcnt(6)
    v_mfma_f32_32x32x16_bf16 v[40:55], v[60:63], v[76:79], v[40:55]
    s_waitcnt lgkmcnt(3)
    v_mfma_f32_32x32x16_bf16 v[40:55], v[64:67], v[80:83], v[40:55]
    s_waitcnt lgkmcnt(0)
    v_mfma_f32_32x32x16_bf16 v[40:55], v[68:71], v[84:87], v[40:55]
    s_cmp_eq_u32 s85, 1
    s_cbranch_scc1 L_dry_ret
    v_mov_b32 v5, 106380
    v_mov_b32 v6, 1
    s_mov_b64 exec, 1
    ds_add_u32 v5, v6
    s_mov_b64 exec, -1
    s_cmp_eq_u32 s31, 0
    s_cbranch_scc0 L_np_37
    v_lshrrev_b32 v5, 2, v1
    v_lshlrev_b32 v5, 9, v5
    v_and_b32 v6, 3, v1
    v_lshlrev_b32 v6, 4, v6
    v_add_u32 v14, v5, v6
    s_mov_b32 s83, 4390912
    s_mov_b32 s84, 4399104
    buffer_load_dwordx4 v[196:199], v14, s[8:11], s83 offen sc1
    buffer_load_dwordx4 v[200:203], v14, s[8:11], s84 offen sc1
L_np_37:
    s_mov_b32 s34, 0x3eb8aa3b
    s_lshl_b32 s36, s31, 11
    s_add_u32 s36, s36, 67584
    s_nop 3
    v_pk_mul_f32 v[40:41], v[40:41], s[34:35] op_sel_hi:[1,0]
    v_pk_mul_f32 v[42:43], v[42:43], s[34:35] op_sel_hi:[1,0]
    v_pk_mul_f32 v[44:45], v[44:45], s[34:35] op_sel_hi:[1,0]
    v_pk_mul_f32 v[46:47], v[46:47], s[34:35] op_sel_hi:[1,0]
    v_pk_mul_f32 v[48:49], v[48:49], s[34:35] op_sel_hi:[1,0]
    v_pk_mul_f32 v[50:51], v[50:51], s[34:35] op_sel_hi:[1,0]
    v_pk_mul_f32 v[52:53], v[52:53], s[34:35] op_sel_hi:[1,0]
    v_pk_mul_f32 v[54:55], v[54:55], s[34:35] op_sel_hi:[1,0]
    v_cvt_pk_bf16_f32 v112, v40, v41
    v_cvt_pk_bf16_f32 v113, v42, v43
    v_cvt_pk_bf16_f32 v114, v44, v45
    v_cvt_pk_bf16_f32 v115, v46, v47
    v_cvt_pk_bf16_f32 v116, v48, v49
    v_cvt_pk_bf16_f32 v117, v50, v51
    v_cvt_pk_bf16_f32 v118, v52, v53
    v_cvt_pk_bf16_f32 v119, v54, v55
    v_add_u32 v7, s36, v2
    v_mov_b32 v5, 106380
    s_mov_b32 s37, 65536
L_ldsw_38:
    ds_read_b32 v6, v5
    s_waitcnt lgkmcnt(0)
    v_readfirstlane_b32 s32, v6
    s_nop 3
    s_cmp_ge_u32 s32, 4
    s_cbranch_scc1 L_ldsd_39
    s_sub_u32 s37, s37, 1
    s_cmp_eq_u32 s37, 0
    s_cbranch_scc1 recurrent_scan__grouped_kv_mqa__swiglu_ffn__prompt_kernel_end
    s_branch L_ldsw_38
L_ldsd_39:
    ds_write_b128 v7, v[112:115]
    ds_write_b128 v7, v[116:119] offset:1024
    v_mov_b32 v5, 106384
    v_add_u32 v5, s44, v5
    v_mov_b32 v6, 1
    s_mov_b64 exec, 1
    ds_add_u32 v5, v6
    s_mov_b64 exec, -1
    v_mul_f32 v88, v40, v40
    v_mul_f32 v89, v48, v48
    v_fma_f32 v88, v41, v41, v88
    v_fma_f32 v89, v49, v49, v89
    v_fma_f32 v88, v42, v42, v88
    v_fma_f32 v89, v50, v50, v89
    v_fma_f32 v88, v43, v43, v88
    v_fma_f32 v89, v51, v51, v89
    v_fma_f32 v88, v44, v44, v88
    v_fma_f32 v89, v52, v52, v89
    v_fma_f32 v88, v45, v45, v88
    v_fma_f32 v89, v53, v53, v89
    v_fma_f32 v88, v46, v46, v88
    v_fma_f32 v89, v54, v54, v89
    v_fma_f32 v88, v47, v47, v88
    v_fma_f32 v89, v55, v55, v89
    v_mov_b32 v5, v88
    s_nop 1
    v_permlane32_swap_b32 v5, v88
    s_nop 1
    v_add_f32 v88, v88, v5
    v_mov_b32 v5, v89
    s_nop 1
    v_permlane32_swap_b32 v5, v89
    s_nop 1
    v_add_f32 v89, v89, v5
    v_max_f32 v88, v88, v89
    s_nop 1
    v_max_f32_dpp v88, v88, v88 row_ror:8 row_mask:0xf bank_mask:0xf
    s_nop 1
    v_max_f32_dpp v88, v88, v88 row_ror:4 row_mask:0xf bank_mask:0xf
    s_nop 1
    v_max_f32_dpp v88, v88, v88 row_ror:2 row_mask:0xf bank_mask:0xf
    s_nop 1
    v_max_f32_dpp v88, v88, v88 row_ror:1 row_mask:0xf bank_mask:0xf
    v_mov_b32 v5, v88
    s_nop 1
    v_permlane16_swap_b32 v5, v88
    s_nop 1
    v_max_f32 v88, v88, v5
    s_lshl_b32 s32, s31, 2
    s_add_u32 s32, s32, 106432
    v_mov_b32 v7, s32
    ds_write_b32 v7, v88
    v_mov_b32 v5, 106420
    v_mov_b32 v6, 1
    s_mov_b64 exec, 1
    ds_add_u32 v5, v6
    s_mov_b64 exec, -1
    v_mov_b32 v5, 106384
    s_mov_b32 s37, 65536
    v_add_u32 v5, s44, v5
L_ldsw_40:
    ds_read_b32 v6, v5
    s_waitcnt lgkmcnt(0)
    v_readfirstlane_b32 s32, v6
    s_nop 3
    s_cmp_ge_u32 s32, 2
    s_cbranch_scc1 L_ldsd_41
    s_sub_u32 s37, s37, 1
    s_cmp_eq_u32 s37, 0
    s_cbranch_scc1 recurrent_scan__grouped_kv_mqa__swiglu_ffn__prompt_kernel_end
    s_branch L_ldsw_40
L_ldsd_41:
    s_xor_b32 s36, s31, 1
    s_lshl_b32 s36, s36, 11
    s_add_u32 s36, s36, 67584
    v_add_u32 v7, s36, v2
    ds_read_b128 v[120:123], v7
    ds_read_b128 v[124:127], v7 offset:1024
    s_cmp_eq_u32 s31, 0
    s_cbranch_scc0 L_wdec_42
    v_mov_b32 v5, 106420
    s_mov_b32 s37, 65536
L_ldsw_44:
    ds_read_b32 v6, v5
    s_waitcnt lgkmcnt(0)
    v_readfirstlane_b32 s32, v6
    s_nop 3
    s_cmp_ge_u32 s32, 4
    s_cbranch_scc1 L_ldsd_45
    s_sub_u32 s37, s37, 1
    s_cmp_eq_u32 s37, 0
    s_cbranch_scc1 recurrent_scan__grouped_kv_mqa__swiglu_ffn__prompt_kernel_end
    s_branch L_ldsw_44
L_ldsd_45:
    v_and_b32 v5, 3, v1
    v_lshlrev_b32 v5, 2, v5
    v_add_u32 v5, 106432, v5
    ds_read_b32 v193, v5
    s_waitcnt lgkmcnt(0)
    s_nop 1
    v_max_f32_dpp v193, v193, v193 row_ror:2 row_mask:0xf bank_mask:0xf
    s_nop 1
    v_max_f32_dpp v193, v193, v193 row_ror:1 row_mask:0xf bank_mask:0xf
    s_mov_b32 s37, 65536
L_kvp_46:
    buffer_load_dwordx4 v[204:207], v14, s[8:11], s83 offen sc1
    buffer_load_dwordx4 v[208:211], v14, s[8:11], s84 offen sc1
    s_waitcnt vmcnt(2)
    v_cmp_eq_u32 vcc, s38, v196
    v_cmp_eq_u32 s[96:97], s38, v200
    s_nop 4
    s_and_b64 vcc, vcc, s[96:97]
    s_cmp_eq_u64 vcc, exec
    s_cbranch_scc1 L_kvpd_47
    buffer_load_dwordx4 v[196:199], v14, s[8:11], s83 offen sc1
    buffer_load_dwordx4 v[200:203], v14, s[8:11], s84 offen sc1
    s_waitcnt vmcnt(2)
    v_cmp_eq_u32 vcc, s38, v204
    v_cmp_eq_u32 s[96:97], s38, v208
    s_nop 4
    s_and_b64 vcc, vcc, s[96:97]
    s_cmp_eq_u64 vcc, exec
    s_cbranch_scc1 L_kvp2_48
    s_sub_u32 s37, s37, 1
    s_cmp_eq_u32 s37, 0
    s_cbranch_scc1 recurrent_scan__grouped_kv_mqa__swiglu_ffn__prompt_kernel_end
    s_branch L_kvp_46
L_kvp2_48:
    s_waitcnt vmcnt(0)
    v_mov_b32 v196, v204
    v_mov_b32 v200, v208
    v_mov_b32 v197, v205
    v_mov_b32 v201, v209
    v_mov_b32 v198, v206
    v_mov_b32 v202, v210
    v_mov_b32 v199, v207
    v_mov_b32 v203, v211
L_kvpd_47:
    v_mul_f32 v197, v197, v193
    v_mul_f32 v201, v201, v193
    v_max_f32 v198, v198, v202
    v_mov_b32 v5, 0x45610000
    v_mov_b32 v6, 0x53800000
    v_cmp_le_f32 vcc, v197, v5
    v_cmp_le_f32 s[96:97], v201, v5
    v_cmp_le_f32 s[98:99], v198, v6
    s_nop 4
    s_and_b64 vcc, vcc, s[96:97]
    s_and_b64 vcc, vcc, s[98:99]
    s_cmp_eq_u64 vcc, exec
    s_cselect_b32 s36, 1, 2
    v_mov_b32 v5, 106416
    v_mov_b32 v6, s36
    ds_write_b32 v5, v6
    s_branch L_dec_43
L_wdec_42:
    v_mov_b32 v5, 106368
    s_mov_b32 s37, 65536
L_ldsw_49:
    ds_read_b32 v6, v5
    s_waitcnt lgkmcnt(0)
    v_readfirstlane_b32 s38, v6
    s_nop 3
    s_cmp_ge_u32 s38, 1
    s_cbranch_scc1 L_ldsd_50
    s_sub_u32 s37, s37, 1
    s_cmp_eq_u32 s37, 0
    s_cbranch_scc1 recurrent_scan__grouped_kv_mqa__swiglu_ffn__prompt_kernel_end
    s_sleep 1
    s_branch L_ldsw_49
L_ldsd_50:
    v_mov_b32 v5, 106416
    s_mov_b32 s37, 65536
L_ldsw_51:
    ds_read_b32 v6, v5
    s_waitcnt lgkmcnt(0)
    v_readfirstlane_b32 s36, v6
    s_nop 3
    s_cmp_ge_u32 s36, 1
    s_cbranch_scc1 L_ldsd_52
    s_sub_u32 s37, s37, 1
    s_cmp_eq_u32 s37, 0
    s_cbranch_scc1 recurrent_scan__grouped_kv_mqa__swiglu_ffn__prompt_kernel_end
    s_sleep 2
    s_branch L_ldsw_51
L_ldsd_52:
L_dec_43:
    s_cmp_eq_u32 s36, 1
    s_cbranch_scc0 L_slow_53
    s_mov_b32 s98, s70
    s_mov_b32 s99, s71
    global_load_dwordx4 v[144:147], v9, s[98:99] sc1
    global_load_dwordx4 v[160:163], v3, s[98:99] offset:1024 sc1
    global_load_dwordx4 v[164:167], v3, s[98:99] offset:2048 sc1
    s_add_u32 s98, s98, 4096
    s_addc_u32 s99, s99, 0
    global_load_dwordx4 v[148:151], v9, s[98:99] sc1
    global_load_dwordx4 v[168:171], v3, s[98:99] offset:1024 sc1
    global_load_dwordx4 v[172:175], v3, s[98:99] offset:2048 sc1
    s_add_u32 s98, s98, 4096
    s_addc_u32 s99, s99, 0
    global_load_dwordx4 v[152:155], v9, s[98:99] sc1
    global_load_dwordx4 v[176:179], v3, s[98:99] offset:1024 sc1
    global_load_dwordx4 v[180:183], v3, s[98:99] offset:2048 sc1
    s_add_u32 s98, s98, 4096
    s_addc_u32 s99, s99, 0
    s_lshl_b32 s81, s28, 1
    s_add_u32 s81, s81, s46
    s_lshl_b32 s81, s81, 5
    s_lshl_b32 s33, s29, 2
    s_add_u32 s81, s81, s33
    s_lshl_b32 s33, s47, 1
    s_add_u32 s81, s81, s33
    s_lshl_b32 s81, s81, 10
    s_add_u32 s81, s81, 12582912
    s_lshl_b32 s82, s28, 9
    s_lshl_b32 s33, s46, 7
    s_add_u32 s82, s82, s33
    s_lshl_b32 s33, s29, 3
    s_add_u32 s82, s82, s33
    s_lshl_b32 s33, s47, 2
    s_add_u32 s82, s82, s33
    s_add_u32 s82, s82, 4391168
    v_mov_b32 v184, 0
    v_mov_b32 v104, 0
    v_mov_b32 v185, 0
    v_mov_b32 v105, 0
    v_mov_b32 v186, 0
    v_mov_b32 v106, 0
    v_mov_b32 v187, 0
    v_mov_b32 v107, 0
    v_mov_b32 v188, 0
    v_mov_b32 v108, 0
    v_mov_b32 v189, 0
    v_mov_b32 v109, 0
    v_mov_b32 v190, 0
    v_mov_b32 v110, 0
    v_mov_b32 v191, 0
    v_mov_b32 v111, 0
    v_pk_mul_f32 v[16:17], v[104:105], v[104:105]
    v_pk_mul_f32 v[18:19], v[104:105], v[104:105]
    v_pk_mul_f32 v[20:21], v[104:105], v[104:105]
    v_pk_mul_f32 v[22:23], v[104:105], v[104:105]
    v_pk_mul_f32 v[24:25], v[104:105], v[104:105]
    v_pk_mul_f32 v[26:27], v[104:105], v[104:105]
    v_pk_mul_f32 v[28:29], v[104:105], v[104:105]
    v_pk_mul_f32 v[30:31], v[104:105], v[104:105]
    v_pk_mul_f32 v[32:33], v[104:105], v[104:105]
    v_pk_mul_f32 v[34:35], v[104:105], v[104:105]
    v_pk_mul_f32 v[36:37], v[104:105], v[104:105]
    v_pk_mul_f32 v[38:39], v[104:105], v[104:105]
    v_pk_mul_f32 v[40:41], v[104:105], v[104:105]
    v_pk_mul_f32 v[42:43], v[104:105], v[104:105]
    v_pk_mul_f32 v[44:45], v[104:105], v[104:105]
    v_pk_mul_f32 v[46:47], v[104:105], v[104:105]
    v_pk_mul_f32 v[48:49], v[104:105], v[104:105]
    v_pk_mul_f32 v[50:51], v[104:105], v[104:105]
    v_pk_mul_f32 v[52:53], v[104:105], v[104:105]
    v_pk_mul_f32 v[54:55], v[104:105], v[104:105]
    v_pk_mul_f32 v[56:57], v[104:105], v[104:105]
    v_pk_mul_f32 v[58:59], v[104:105], v[104:105]
    v_pk_mul_f32 v[60:61], v[104:105], v[104:105]
    v_pk_mul_f32 v[62:63], v[104:105], v[104:105]
    v_pk_mul_f32 v[64:65], v[104:105], v[104:105]
    v_pk_mul_f32 v[66:67], v[104:105], v[104:105]
    v_pk_mul_f32 v[68:69], v[104:105], v[104:105]
    v_pk_mul_f32 v[70:71], v[104:105], v[104:105]
    v_pk_mul_f32 v[72:73], v[104:105], v[104:105]
    v_pk_mul_f32 v[74:75], v[104:105], v[104:105]
    v_pk_mul_f32 v[76:77], v[104:105], v[104:105]
    v_pk_mul_f32 v[78:79], v[104:105], v[104:105]
    s_waitcnt vmcnt(6) lgkmcnt(0)
    v_mfma_f32_32x32x16_bf16 v[80:95], v[144:147], v[112:115], 0
    s_nop 11
    s_mov_b32 s45, 8
L_aloop_55:
    v_exp_f32 v80, v80
    v_exp_f32 v81, v81
    v_smfmac_f32_32x32x32_bf16 v[64:79], v[188:191], v[104:111], v8
    global_load_dwordx4 v[156:159], v9, s[98:99] sc1
    global_load_dwordx4 v[184:187], v3, s[98:99] offset:1024 sc1
    global_load_dwordx4 v[188:191], v3, s[98:99] offset:2048 sc1
    v_exp_f32 v82, v82
    s_add_u32 s98, s98, 4096
    v_exp_f32 v83, v83
    s_addc_u32 s99, s99, 0
    v_exp_f32 v84, v84
    v_exp_f32 v85, v85
    v_exp_f32 v86, v86
    v_mfma_f32_32x32x16_bf16 v[96:111], v[144:147], v[116:119], 0
    v_exp_f32 v87, v87
    v_exp_f32 v88, v88
    v_exp_f32 v89, v89
    v_exp_f32 v90, v90
    v_exp_f32 v91, v91
    v_smfmac_f32_32x32x32_bf16 v[16:31], v[160:163], v[80:87], v8
    v_exp_f32 v92, v92
    v_exp_f32 v93, v93
    v_exp_f32 v94, v94
    v_exp_f32 v95, v95
    v_exp_f32 v96, v96
    v_exp_f32 v97, v97
    v_smfmac_f32_32x32x32_bf16 v[16:31], v[164:167], v[88:95], v8
    v_exp_f32 v98, v98
    v_exp_f32 v99, v99
    v_exp_f32 v100, v100
    v_exp_f32 v101, v101
    v_exp_f32 v102, v102
    v_mfma_f32_32x32x16_bf16 v[80:95], v[144:147], v[120:123], 0
    v_exp_f32 v103, v103
    v_exp_f32 v104, v104
    v_exp_f32 v105, v105
    v_exp_f32 v106, v106
    v_exp_f32 v107, v107
    v_smfmac_f32_32x32x32_bf16 v[32:47], v[160:163], v[96:103], v8
    v_exp_f32 v108, v108
    v_exp_f32 v109, v109
    v_exp_f32 v110, v110
    v_exp_f32 v111, v111
    v_exp_f32 v80, v80
    v_exp_f32 v81, v81
    v_smfmac_f32_32x32x32_bf16 v[32:47], v[164:167], v[104:111], v8
    v_exp_f32 v82, v82
    v_exp_f32 v83, v83
    v_exp_f32 v84, v84
    v_exp_f32 v85, v85
    v_exp_f32 v86, v86
    v_mfma_f32_32x32x16_bf16 v[96:111], v[144:147], v[124:127], 0
    v_exp_f32 v87, v87
    v_exp_f32 v88, v88
    v_exp_f32 v89, v89
    v_exp_f32 v90, v90
    v_exp_f32 v91, v91
    v_smfmac_f32_32x32x32_bf16 v[48:63], v[160:163], v[80:87], v8
    v_exp_f32 v92, v92
    v_exp_f32 v93, v93
    v_exp_f32 v94, v94
    v_exp_f32 v95, v95
    v_exp_f32 v96, v96
    v_exp_f32 v97, v97
    v_smfmac_f32_32x32x32_bf16 v[48:63], v[164:167], v[88:95], v8
    v_exp_f32 v98, v98
    v_exp_f32 v99, v99
    v_exp_f32 v100, v100
    v_exp_f32 v101, v101
    v_exp_f32 v102, v102
    s_waitcnt vmcnt(6)
    v_mfma_f32_32x32x16_bf16 v[80:95], v[148:151], v[112:115], 0
    v_exp_f32 v103, v103
    v_exp_f32 v104, v104
    v_exp_f32 v105, v105
    v_exp_f32 v106, v106
    v_exp_f32 v107, v107
    v_smfmac_f32_32x32x32_bf16 v[64:79], v[160:163], v[96:103], v8
    v_exp_f32 v108, v108
    v_exp_f32 v109, v109
    v_exp_f32 v110, v110
    v_exp_f32 v111, v111
    v_exp_f32 v80, v80
    v_exp_f32 v81, v81
    v_smfmac_f32_32x32x32_bf16 v[64:79], v[164:167], v[104:111], v8
    global_load_dwordx4 v[144:147], v9, s[98:99] sc1
    global_load_dwordx4 v[160:163], v3, s[98:99] offset:1024 sc1
    global_load_dwordx4 v[164:167], v3, s[98:99] offset:2048 sc1
    v_exp_f32 v82, v82
    s_add_u32 s98, s98, 4096
    v_exp_f32 v83, v83
    s_addc_u32 s99, s99, 0
    v_exp_f32 v84, v84
    v_exp_f32 v85, v85
    v_exp_f32 v86, v86
    v_mfma_f32_32x32x16_bf16 v[96:111], v[148:151], v[116:119], 0
    v_exp_f32 v87, v87
    v_exp_f32 v88, v88
    v_exp_f32 v89, v89
    v_exp_f32 v90, v90
    v_exp_f32 v91, v91
    v_smfmac_f32_32x32x32_bf16 v[16:31], v[168:171], v[80:87], v8
    v_exp_f32 v92, v92
    v_exp_f32 v93, v93
    v_exp_f32 v94, v94
    v_exp_f32 v95, v95
    v_exp_f32 v96, v96
    v_exp_f32 v97, v97
    v_smfmac_f32_32x32x32_bf16 v[16:31], v[172:175], v[88:95], v8
    v_exp_f32 v98, v98
    v_exp_f32 v99, v99
    v_exp_f32 v100, v100
    v_exp_f32 v101, v101
    v_exp_f32 v102, v102
    v_mfma_f32_32x32x16_bf16 v[80:95], v[148:151], v[120:123], 0
    v_exp_f32 v103, v103
    v_exp_f32 v104, v104
    v_exp_f32 v105, v105
    v_exp_f32 v106, v106
    v_exp_f32 v107, v107
    v_smfmac_f32_32x32x32_bf16 v[32:47], v[168:171], v[96:103], v8
    v_exp_f32 v108, v108
    v_exp_f32 v109, v109
    v_exp_f32 v110, v110
    v_exp_f32 v111, v111
    v_exp_f32 v80, v80
    v_exp_f32 v81, v81
    v_smfmac_f32_32x32x32_bf16 v[32:47], v[172:175], v[104:111], v8
    v_exp_f32 v82, v82
    v_exp_f32 v83, v83
    v_exp_f32 v84, v84
    v_exp_f32 v85, v85
    v_exp_f32 v86, v86
    v_mfma_f32_32x32x16_bf16 v[96:111], v[148:151], v[124:127], 0
    v_exp_f32 v87, v87
    v_exp_f32 v88, v88
    v_exp_f32 v89, v89
    v_exp_f32 v90, v90
    v_exp_f32 v91, v91
    v_smfmac_f32_32x32x32_bf16 v[48:63], v[168:171], v[80:87], v8
    v_exp_f32 v92, v92
    v_exp_f32 v93, v93
    v_exp_f32 v94, v94
    v_exp_f32 v95, v95
    v_exp_f32 v96, v96
    v_exp_f32 v97, v97
    v_smfmac_f32_32x32x32_bf16 v[48:63], v[172:175], v[88:95], v8
    v_exp_f32 v98, v98
    v_exp_f32 v99, v99
    v_exp_f32 v100, v100
    v_exp_f32 v101, v101
    v_exp_f32 v102, v102
    s_waitcnt vmcnt(6)
    v_mfma_f32_32x32x16_bf16 v[80:95], v[152:155], v[112:115], 0
    v_exp_f32 v103, v103
    v_exp_f32 v104, v104
    v_exp_f32 v105, v105
    v_exp_f32 v106, v106
    v_exp_f32 v107, v107
    v_smfmac_f32_32x32x32_bf16 v[64:79], v[168:171], v[96:103], v8
    v_exp_f32 v108, v108
    v_exp_f32 v109, v109
    v_exp_f32 v110, v110
    v_exp_f32 v111, v111
    v_exp_f32 v80, v80
    v_exp_f32 v81, v81
    v_smfmac_f32_32x32x32_bf16 v[64:79], v[172:175], v[104:111], v8
    global_load_dwordx4 v[148:151], v9, s[98:99] sc1
    global_load_dwordx4 v[168:171], v3, s[98:99] offset:1024 sc1
    global_load_dwordx4 v[172:175], v3, s[98:99] offset:2048 sc1
    v_exp_f32 v82, v82
    s_add_u32 s98, s98, 4096
    v_exp_f32 v83, v83
    s_addc_u32 s99, s99, 0
    v_exp_f32 v84, v84
    v_exp_f32 v85, v85
    v_exp_f32 v86, v86
    v_mfma_f32_32x32x16_bf16 v[96:111], v[152:155], v[116:119], 0
    v_exp_f32 v87, v87
    v_exp_f32 v88, v88
    v_exp_f32 v89, v89
    v_exp_f32 v90, v90
    v_exp_f32 v91, v91
    v_smfmac_f32_32x32x32_bf16 v[16:31], v[176:179], v[80:87], v8
    v_exp_f32 v92, v92
    v_exp_f32 v93, v93
    v_exp_f32 v94, v94
    v_exp_f32 v95, v95
    v_exp_f32 v96, v96
    v_exp_f32 v97, v97
    v_smfmac_f32_32x32x32_bf16 v[16:31], v[180:183], v[88:95], v8
    v_exp_f32 v98, v98
    v_exp_f32 v99, v99
    v_exp_f32 v100, v100
    v_exp_f32 v101, v101
    v_exp_f32 v102, v102
    v_mfma_f32_32x32x16_bf16 v[80:95], v[152:155], v[120:123], 0
    v_exp_f32 v103, v103
    v_exp_f32 v104, v104
    v_exp_f32 v105, v105
    v_exp_f32 v106, v106
    v_exp_f32 v107, v107
    v_smfmac_f32_32x32x32_bf16 v[32:47], v[176:179], v[96:103], v8
    v_exp_f32 v108, v108
    v_exp_f32 v109, v109
    v_exp_f32 v110, v110
    v_exp_f32 v111, v111
    v_exp_f32 v80, v80
    v_exp_f32 v81, v81
    v_smfmac_f32_32x32x32_bf16 v[32:47], v[180:183], v[104:111], v8
    v_exp_f32 v82, v82
    v_exp_f32 v83, v83
    v_exp_f32 v84, v84
    v_exp_f32 v85, v85
    v_exp_f32 v86, v86
    v_mfma_f32_32x32x16_bf16 v[96:111], v[152:155], v[124:127], 0
    v_exp_f32 v87, v87
    v_exp_f32 v88, v88
    v_exp_f32 v89, v89
    v_exp_f32 v90, v90
    v_exp_f32 v91, v91
    v_smfmac_f32_32x32x32_bf16 v[48:63], v[176:179], v[80:87], v8
    v_exp_f32 v92, v92
    v_exp_f32 v93, v93
    v_exp_f32 v94, v94
    v_exp_f32 v95, v95
    v_exp_f32 v96, v96
    v_exp_f32 v97, v97
    v_smfmac_f32_32x32x32_bf16 v[48:63], v[180:183], v[88:95], v8
    v_exp_f32 v98, v98
    v_exp_f32 v99, v99
    v_exp_f32 v100, v100
    v_exp_f32 v101, v101
    v_exp_f32 v102, v102
    s_waitcnt vmcnt(6)
    v_mfma_f32_32x32x16_bf16 v[80:95], v[156:159], v[112:115], 0
    v_exp_f32 v103, v103
    v_exp_f32 v104, v104
    v_exp_f32 v105, v105
    v_exp_f32 v106, v106
    v_exp_f32 v107, v107
    v_smfmac_f32_32x32x32_bf16 v[64:79], v[176:179], v[96:103], v8
    v_exp_f32 v108, v108
    v_exp_f32 v109, v109
    v_exp_f32 v110, v110
    v_exp_f32 v111, v111
    v_exp_f32 v80, v80
    v_exp_f32 v81, v81
    v_smfmac_f32_32x32x32_bf16 v[64:79], v[180:183], v[104:111], v8
    global_load_dwordx4 v[152:155], v9, s[98:99] sc1
    global_load_dwordx4 v[176:179], v3, s[98:99] offset:1024 sc1
    global_load_dwordx4 v[180:183], v3, s[98:99] offset:2048 sc1
    v_exp_f32 v82, v82
    s_add_u32 s98, s98, 4096
    v_exp_f32 v83, v83
    s_addc_u32 s99, s99, 0
    v_exp_f32 v84, v84
    v_exp_f32 v85, v85
    v_exp_f32 v86, v86
    v_mfma_f32_32x32x16_bf16 v[96:111], v[156:159], v[116:119], 0
    v_exp_f32 v87, v87
    v_exp_f32 v88, v88
    v_exp_f32 v89, v89
    v_exp_f32 v90, v90
    v_exp_f32 v91, v91
    v_smfmac_f32_32x32x32_bf16 v[16:31], v[184:187], v[80:87], v8
    v_exp_f32 v92, v92
    v_exp_f32 v93, v93
    v_exp_f32 v94, v94
    v_exp_f32 v95, v95
    v_exp_f32 v96, v96
    v_exp_f32 v97, v97
    v_smfmac_f32_32x32x32_bf16 v[16:31], v[188:191], v[88:95], v8
    v_exp_f32 v98, v98
    v_exp_f32 v99, v99
    v_exp_f32 v100, v100
    v_exp_f32 v101, v101
    v_exp_f32 v102, v102
    v_mfma_f32_32x32x16_bf16 v[80:95], v[156:159], v[120:123], 0
    v_exp_f32 v103, v103
    v_exp_f32 v104, v104
    v_exp_f32 v105, v105
    v_exp_f32 v106, v106
    v_exp_f32 v107, v107
    v_smfmac_f32_32x32x32_bf16 v[32:47], v[184:187], v[96:103], v8
    v_exp_f32 v108, v108
    v_exp_f32 v109, v109
    v_exp_f32 v110, v110
    v_exp_f32 v111, v111
    v_exp_f32 v80, v80
    v_exp_f32 v81, v81
    v_smfmac_f32_32x32x32_bf16 v[32:47], v[188:191], v[104:111], v8
    v_exp_f32 v82, v82
    v_exp_f32 v83, v83
    v_exp_f32 v84, v84
    v_exp_f32 v85, v85
    v_exp_f32 v86, v86
    v_mfma_f32_32x32x16_bf16 v[96:111], v[156:159], v[124:127], 0
    v_exp_f32 v87, v87
    v_exp_f32 v88, v88
    v_exp_f32 v89, v89
    v_exp_f32 v90, v90
    v_exp_f32 v91, v91
    v_smfmac_f32_32x32x32_bf16 v[48:63], v[184:187], v[80:87], v8
    v_exp_f32 v92, v92
    v_exp_f32 v93, v93
    v_exp_f32 v94, v94
    v_exp_f32 v95, v95
    v_exp_f32 v96, v96
    v_exp_f32 v97, v97
    v_smfmac_f32_32x32x32_bf16 v[48:63], v[188:191], v[88:95], v8
    v_exp_f32 v98, v98
    v_exp_f32 v99, v99
    v_exp_f32 v100, v100
    v_exp_f32 v101, v101
    v_exp_f32 v102, v102
    s_waitcnt vmcnt(6)
    v_mfma_f32_32x32x16_bf16 v[80:95], v[144:147], v[112:115], 0
    v_exp_f32 v103, v103
    v_exp_f32 v104, v104
    v_exp_f32 v105, v105
    v_exp_f32 v106, v106
    v_exp_f32 v107, v107
    v_smfmac_f32_32x32x32_bf16 v[64:79], v[184:187], v[96:103], v8
    v_exp_f32 v108, v108
    s_sub_u32 s45, s45, 1
    v_exp_f32 v109, v109
    s_cmp_lg_u32 s45, 0
    v_exp_f32 v110, v110
    v_exp_f32 v111, v111
    s_cbranch_scc1 L_aloop_55
    s_nop 0
    v_smfmac_f32_32x32x32_bf16 v[64:79], v[188:191], v[104:111], v8
    ds_write_b128 v10, v[48:51]
    ds_write_b128 v10, v[52:55] offset:1024
    ds_write_b32 v11, v56 offset:2048
    s_nop 9
    ds_write_b128 v10, v[64:67] offset:2304
    ds_write_b128 v10, v[68:71] offset:3328
    ds_write_b32 v11, v72 offset:4352
    v_mov_b32 v5, 106392
    v_add_u32 v5, s44, v5
    v_mov_b32 v6, 1
    s_mov_b64 exec, 1
    ds_add_u32 v5, v6
    s_mov_b64 exec, -1
    v_mov_b32 v5, 106392
    s_mov_b32 s37, 65536
    v_add_u32 v5, s44, v5
L_ldsw_56:
    ds_read_b32 v6, v5
    s_waitcnt lgkmcnt(0)
    v_readfirstlane_b32 s32, v6
    s_nop 3
    s_cmp_ge_u32 s32, 2
    s_cbranch_scc1 L_ldsd_57
    s_sub_u32 s37, s37, 1
    s_cmp_eq_u32 s37, 0
    s_cbranch_scc1 recurrent_scan__grouped_kv_mqa__swiglu_ffn__prompt_kernel_end
    s_branch L_ldsw_56
L_ldsd_57:
    ds_read_b128 v[48:51], v12 offset:0
    ds_read_b128 v[52:55], v12 offset:1024
    ds_read_b32 v56, v13 offset:2048
    ds_read_b128 v[64:67], v12 offset:2304
    ds_read_b128 v[68:71], v12 offset:3328
    ds_read_b32 v72, v13 offset:4352
    s_waitcnt lgkmcnt(3)
    v_add_f32 v24, v24, v56
    v_rcp_f32 v24, v24
    v_pk_add_f32 v[16:17], v[16:17], v[48:49]
    v_pk_add_f32 v[18:19], v[18:19], v[50:51]
    v_pk_add_f32 v[20:21], v[20:21], v[52:53]
    v_pk_add_f32 v[22:23], v[22:23], v[54:55]
    v_pk_mul_f32 v[16:17], v[16:17], v[24:25] op_sel_hi:[1,0]
    v_pk_mul_f32 v[18:19], v[18:19], v[24:25] op_sel_hi:[1,0]
    v_pk_mul_f32 v[20:21], v[20:21], v[24:25] op_sel_hi:[1,0]
    v_pk_mul_f32 v[22:23], v[22:23], v[24:25] op_sel_hi:[1,0]
    s_waitcnt lgkmcnt(0)
    v_add_f32 v40, v40, v72
    v_rcp_f32 v40, v40
    v_pk_add_f32 v[32:33], v[32:33], v[64:65]
    v_pk_add_f32 v[34:35], v[34:35], v[66:67]
    v_pk_add_f32 v[36:37], v[36:37], v[68:69]
    v_pk_add_f32 v[38:39], v[38:39], v[70:71]
    v_pk_mul_f32 v[32:33], v[32:33], v[40:41] op_sel_hi:[1,0]
    v_pk_mul_f32 v[34:35], v[34:35], v[40:41] op_sel_hi:[1,0]
    v_pk_mul_f32 v[36:37], v[36:37], v[40:41] op_sel_hi:[1,0]
    v_pk_mul_f32 v[38:39], v[38:39], v[40:41] op_sel_hi:[1,0]
    v_cvt_pk_bf16_f32 v192, v16, v17
    v_cvt_pk_bf16_f32 v193, v18, v19
    v_cvt_pk_bf16_f32 v194, v20, v21
    v_cvt_pk_bf16_f32 v195, v22, v23
    buffer_store_dwordx4 v[192:195], v2, s[8:11], s81 offen offset:0 sc1
    v_cvt_pk_bf16_f32 v196, v32, v33
    v_cvt_pk_bf16_f32 v197, v34, v35
    v_cvt_pk_bf16_f32 v198, v36, v37
    v_cvt_pk_bf16_f32 v199, v38, v39
    buffer_store_dwordx4 v[196:199], v2, s[8:11], s81 offen offset:1024 sc1
    s_waitcnt vmcnt(0)
    v_mov_b32 v5, 0
    v_mov_b32 v6, s38
    s_mov_b64 exec, 1
    buffer_store_dword v6, v5, s[8:11], s82 offen sc1
    s_mov_b64 exec, -1
    s_branch recurrent_scan__grouped_kv_mqa__swiglu_ffn__prompt_kernel_end
L_slow_53:
    s_lshl_b32 s81, s28, 1
    s_add_u32 s81, s81, s46
    s_lshl_b32 s81, s81, 5
    s_lshl_b32 s33, s29, 2
    s_add_u32 s81, s81, s33
    s_lshl_b32 s33, s47, 1
    s_add_u32 s81, s81, s33
    s_lshl_b32 s81, s81, 10
    s_add_u32 s81, s81, 12582912
    s_lshl_b32 s82, s28, 9
    s_lshl_b32 s33, s46, 7
    s_add_u32 s82, s82, s33
    s_lshl_b32 s33, s29, 3
    s_add_u32 s82, s82, s33
    s_lshl_b32 s33, s47, 2
    s_add_u32 s82, s82, s33
    s_add_u32 s82, s82, 4391168
    s_mov_b32 s96, 0
    s_mov_b32 s97, -1
    s_waitcnt lgkmcnt(0)
    v_mov_b32 v200, 0xff800000
    s_mov_b32 s98, s70
    s_mov_b32 s99, s71
    s_mov_b32 s45, 32
L_smax_58:
    global_load_dwordx4 v[144:147], v9, s[98:99] sc1
    s_waitcnt vmcnt(0)
    v_mfma_f32_32x32x16_bf16 v[80:95], v[144:147], v[112:115], 0
    s_nop 15
    v_max3_f32 v200, v80, v81, v200
    v_max3_f32 v200, v82, v83, v200
    v_max3_f32 v200, v84, v85, v200
    v_max3_f32 v200, v86, v87, v200
    v_max3_f32 v200, v88, v89, v200
    v_max3_f32 v200, v90, v91, v200
    v_max3_f32 v200, v92, v93, v200
    v_max3_f32 v200, v94, v95, v200
    s_add_u32 s98, s98, 4096
    s_addc_u32 s99, s99, 0
    s_sub_u32 s45, s45, 1
    s_cmp_lg_u32 s45, 0
    s_cbranch_scc1 L_smax_58
    v_mov_b32 v5, v200
    s_nop 1
    v_permlane32_swap_b32 v5, v200
    s_nop 1
    v_max_f32 v200, v200, v5
    v_mov_b32 v16, 0
    v_mov_b32 v17, 0
    v_mov_b32 v18, 0
    v_mov_b32 v19, 0
    v_mov_b32 v20, 0
    v_mov_b32 v21, 0
    v_mov_b32 v22, 0
    v_mov_b32 v23, 0
    v_mov_b32 v24, 0
    v_mov_b32 v25, 0
    v_mov_b32 v26, 0
    v_mov_b32 v27, 0
    v_mov_b32 v28, 0
    v_mov_b32 v29, 0
    v_mov_b32 v30, 0
    v_mov_b32 v31, 0
    s_mov_b32 s98, s70
    s_mov_b32 s99, s71
    s_mov_b32 s45, 32
L_spv_59:
    global_load_dwordx4 v[144:147], v9, s[98:99] sc1
    global_load_dwordx4 v[160:163], v3, s[98:99] offset:1024 sc1
    global_load_dwordx4 v[164:167], v3, s[98:99] offset:2048 sc1
    s_waitcnt vmcnt(0)
    v_mfma_f32_32x32x16_bf16 v[80:95], v[144:147], v[112:115], 0
    s_nop 15
    v_sub_f32 v80, v80, v200
    v_sub_f32 v81, v81, v200
    v_sub_f32 v82, v82, v200
    v_sub_f32 v83, v83, v200
    v_sub_f32 v84, v84, v200
    v_sub_f32 v85, v85, v200
    v_sub_f32 v86, v86, v200
    v_sub_f32 v87, v87, v200
    v_sub_f32 v88, v88, v200
    v_sub_f32 v89, v89, v200
    v_sub_f32 v90, v90, v200
    v_sub_f32 v91, v91, v200
    v_sub_f32 v92, v92, v200
    v_sub_f32 v93, v93, v200
    v_sub_f32 v94, v94, v200
    v_sub_f32 v95, v95, v200
    v_exp_f32 v80, v80
    v_exp_f32 v81, v81
    v_exp_f32 v82, v82
    v_exp_f32 v83, v83
    v_exp_f32 v84, v84
    v_exp_f32 v85, v85
    v_exp_f32 v86, v86
    v_exp_f32 v87, v87
    v_exp_f32 v88, v88
    v_exp_f32 v89, v89
    v_exp_f32 v90, v90
    v_exp_f32 v91, v91
    v_exp_f32 v92, v92
    v_exp_f32 v93, v93
    v_exp_f32 v94, v94
    v_exp_f32 v95, v95
    s_nop 1
    v_smfmac_f32_32x32x32_bf16 v[16:31], v[160:163], v[80:87], v8
    v_smfmac_f32_32x32x32_bf16 v[16:31], v[164:167], v[88:95], v8
    s_nop 15
    s_add_u32 s98, s98, 4096
    s_addc_u32 s99, s99, 0
    s_sub_u32 s45, s45, 1
    s_cmp_lg_u32 s45, 0
    s_cbranch_scc1 L_spv_59
    v_mov_b32 v25, v200
    v_mov_b32 v200, 0xff800000
    s_mov_b32 s98, s70
    s_mov_b32 s99, s71
    s_mov_b32 s45, 32
L_smax_60:
    global_load_dwordx4 v[144:147], v9, s[98:99] sc1
    s_waitcnt vmcnt(0)
    v_mfma_f32_32x32x16_bf16 v[80:95], v[144:147], v[116:119], 0
    s_nop 15
    v_max3_f32 v200, v80, v81, v200
    v_max3_f32 v200, v82, v83, v200
    v_max3_f32 v200, v84, v85, v200
    v_max3_f32 v200, v86, v87, v200
    v_max3_f32 v200, v88, v89, v200
    v_max3_f32 v200, v90, v91, v200
    v_max3_f32 v200, v92, v93, v200
    v_max3_f32 v200, v94, v95, v200
    s_add_u32 s98, s98, 4096
    s_addc_u32 s99, s99, 0
    s_sub_u32 s45, s45, 1
    s_cmp_lg_u32 s45, 0
    s_cbranch_scc1 L_smax_60
    v_mov_b32 v5, v200
    s_nop 1
    v_permlane32_swap_b32 v5, v200
    s_nop 1
    v_max_f32 v200, v200, v5
    v_mov_b32 v32, 0
    v_mov_b32 v33, 0
    v_mov_b32 v34, 0
    v_mov_b32 v35, 0
    v_mov_b32 v36, 0
    v_mov_b32 v37, 0
    v_mov_b32 v38, 0
    v_mov_b32 v39, 0
    v_mov_b32 v40, 0
    v_mov_b32 v41, 0
    v_mov_b32 v42, 0
    v_mov_b32 v43, 0
    v_mov_b32 v44, 0
    v_mov_b32 v45, 0
    v_mov_b32 v46, 0
    v_mov_b32 v47, 0
    s_mov_b32 s98, s70
    s_mov_b32 s99, s71
    s_mov_b32 s45, 32
L_spv_61:
    global_load_dwordx4 v[144:147], v9, s[98:99] sc1
    global_load_dwordx4 v[160:163], v3, s[98:99] offset:1024 sc1
    global_load_dwordx4 v[164:167], v3, s[98:99] offset:2048 sc1
    s_waitcnt vmcnt(0)
    v_mfma_f32_32x32x16_bf16 v[80:95], v[144:147], v[116:119], 0
    s_nop 15
    v_sub_f32 v80, v80, v200
    v_sub_f32 v81, v81, v200
    v_sub_f32 v82, v82, v200
    v_sub_f32 v83, v83, v200
    v_sub_f32 v84, v84, v200
    v_sub_f32 v85, v85, v200
    v_sub_f32 v86, v86, v200
    v_sub_f32 v87, v87, v200
    v_sub_f32 v88, v88, v200
    v_sub_f32 v89, v89, v200
    v_sub_f32 v90, v90, v200
    v_sub_f32 v91, v91, v200
    v_sub_f32 v92, v92, v200
    v_sub_f32 v93, v93, v200
    v_sub_f32 v94, v94, v200
    v_sub_f32 v95, v95, v200
    v_exp_f32 v80, v80
    v_exp_f32 v81, v81
    v_exp_f32 v82, v82
    v_exp_f32 v83, v83
    v_exp_f32 v84, v84
    v_exp_f32 v85, v85
    v_exp_f32 v86, v86
    v_exp_f32 v87, v87
    v_exp_f32 v88, v88
    v_exp_f32 v89, v89
    v_exp_f32 v90, v90
    v_exp_f32 v91, v91
    v_exp_f32 v92, v92
    v_exp_f32 v93, v93
    v_exp_f32 v94, v94
    v_exp_f32 v95, v95
    s_nop 1
    v_smfmac_f32_32x32x32_bf16 v[32:47], v[160:163], v[80:87], v8
    v_smfmac_f32_32x32x32_bf16 v[32:47], v[164:167], v[88:95], v8
    s_nop 15
    s_add_u32 s98, s98, 4096
    s_addc_u32 s99, s99, 0
    s_sub_u32 s45, s45, 1
    s_cmp_lg_u32 s45, 0
    s_cbranch_scc1 L_spv_61
    v_mov_b32 v41, v200
    v_mov_b32 v200, 0xff800000
    s_mov_b32 s98, s70
    s_mov_b32 s99, s71
    s_mov_b32 s45, 32
L_smax_62:
    global_load_dwordx4 v[144:147], v9, s[98:99] sc1
    s_waitcnt vmcnt(0)
    v_mfma_f32_32x32x16_bf16 v[80:95], v[144:147], v[120:123], 0
    s_nop 15
    v_max3_f32 v200, v80, v81, v200
    v_max3_f32 v200, v82, v83, v200
    v_max3_f32 v200, v84, v85, v200
    v_max3_f32 v200, v86, v87, v200
    v_max3_f32 v200, v88, v89, v200
    v_max3_f32 v200, v90, v91, v200
    v_max3_f32 v200, v92, v93, v200
    v_max3_f32 v200, v94, v95, v200
    s_add_u32 s98, s98, 4096
    s_addc_u32 s99, s99, 0
    s_sub_u32 s45, s45, 1
    s_cmp_lg_u32 s45, 0
    s_cbranch_scc1 L_smax_62
    v_mov_b32 v5, v200
    s_nop 1
    v_permlane32_swap_b32 v5, v200
    s_nop 1
    v_max_f32 v200, v200, v5
    v_mov_b32 v48, 0
    v_mov_b32 v49, 0
    v_mov_b32 v50, 0
    v_mov_b32 v51, 0
    v_mov_b32 v52, 0
    v_mov_b32 v53, 0
    v_mov_b32 v54, 0
    v_mov_b32 v55, 0
    v_mov_b32 v56, 0
    v_mov_b32 v57, 0
    v_mov_b32 v58, 0
    v_mov_b32 v59, 0
    v_mov_b32 v60, 0
    v_mov_b32 v61, 0
    v_mov_b32 v62, 0
    v_mov_b32 v63, 0
    s_mov_b32 s98, s70
    s_mov_b32 s99, s71
    s_mov_b32 s45, 32
L_spv_63:
    global_load_dwordx4 v[144:147], v9, s[98:99] sc1
    global_load_dwordx4 v[160:163], v3, s[98:99] offset:1024 sc1
    global_load_dwordx4 v[164:167], v3, s[98:99] offset:2048 sc1
    s_waitcnt vmcnt(0)
    v_mfma_f32_32x32x16_bf16 v[80:95], v[144:147], v[120:123], 0
    s_nop 15
    v_sub_f32 v80, v80, v200
    v_sub_f32 v81, v81, v200
    v_sub_f32 v82, v82, v200
    v_sub_f32 v83, v83, v200
    v_sub_f32 v84, v84, v200
    v_sub_f32 v85, v85, v200
    v_sub_f32 v86, v86, v200
    v_sub_f32 v87, v87, v200
    v_sub_f32 v88, v88, v200
    v_sub_f32 v89, v89, v200
    v_sub_f32 v90, v90, v200
    v_sub_f32 v91, v91, v200
    v_sub_f32 v92, v92, v200
    v_sub_f32 v93, v93, v200
    v_sub_f32 v94, v94, v200
    v_sub_f32 v95, v95, v200
    v_exp_f32 v80, v80
    v_exp_f32 v81, v81
    v_exp_f32 v82, v82
    v_exp_f32 v83, v83
    v_exp_f32 v84, v84
    v_exp_f32 v85, v85
    v_exp_f32 v86, v86
    v_exp_f32 v87, v87
    v_exp_f32 v88, v88
    v_exp_f32 v89, v89
    v_exp_f32 v90, v90
    v_exp_f32 v91, v91
    v_exp_f32 v92, v92
    v_exp_f32 v93, v93
    v_exp_f32 v94, v94
    v_exp_f32 v95, v95
    s_nop 1
    v_smfmac_f32_32x32x32_bf16 v[48:63], v[160:163], v[80:87], v8
    v_smfmac_f32_32x32x32_bf16 v[48:63], v[164:167], v[88:95], v8
    s_nop 15
    s_add_u32 s98, s98, 4096
    s_addc_u32 s99, s99, 0
    s_sub_u32 s45, s45, 1
    s_cmp_lg_u32 s45, 0
    s_cbranch_scc1 L_spv_63
    v_cndmask_b32 v57, v56, v200, s[96:97]
    ds_write_b128 v10, v[48:51] offset:0
    ds_write_b128 v10, v[52:55] offset:1024
    ds_write_b32 v11, v57 offset:2048
    v_mov_b32 v200, 0xff800000
    s_mov_b32 s98, s70
    s_mov_b32 s99, s71
    s_mov_b32 s45, 32
L_smax_64:
    global_load_dwordx4 v[144:147], v9, s[98:99] sc1
    s_waitcnt vmcnt(0)
    v_mfma_f32_32x32x16_bf16 v[80:95], v[144:147], v[124:127], 0
    s_nop 15
    v_max3_f32 v200, v80, v81, v200
    v_max3_f32 v200, v82, v83, v200
    v_max3_f32 v200, v84, v85, v200
    v_max3_f32 v200, v86, v87, v200
    v_max3_f32 v200, v88, v89, v200
    v_max3_f32 v200, v90, v91, v200
    v_max3_f32 v200, v92, v93, v200
    v_max3_f32 v200, v94, v95, v200
    s_add_u32 s98, s98, 4096
    s_addc_u32 s99, s99, 0
    s_sub_u32 s45, s45, 1
    s_cmp_lg_u32 s45, 0
    s_cbranch_scc1 L_smax_64
    v_mov_b32 v5, v200
    s_nop 1
    v_permlane32_swap_b32 v5, v200
    s_nop 1
    v_max_f32 v200, v200, v5
    v_mov_b32 v64, 0
    v_mov_b32 v65, 0
    v_mov_b32 v66, 0
    v_mov_b32 v67, 0
    v_mov_b32 v68, 0
    v_mov_b32 v69, 0
    v_mov_b32 v70, 0
    v_mov_b32 v71, 0
    v_mov_b32 v72, 0
    v_mov_b32 v73, 0
    v_mov_b32 v74, 0
    v_mov_b32 v75, 0
    v_mov_b32 v76, 0
    v_mov_b32 v77, 0
    v_mov_b32 v78, 0
    v_mov_b32 v79, 0
    s_mov_b32 s98, s70
    s_mov_b32 s99, s71
    s_mov_b32 s45, 32
L_spv_65:
    global_load_dwordx4 v[144:147], v9, s[98:99] sc1
    global_load_dwordx4 v[160:163], v3, s[98:99] offset:1024 sc1
    global_load_dwordx4 v[164:167], v3, s[98:99] offset:2048 sc1
    s_waitcnt vmcnt(0)
    v_mfma_f32_32x32x16_bf16 v[80:95], v[144:147], v[124:127], 0
    s_nop 15
    v_sub_f32 v80, v80, v200
    v_sub_f32 v81, v81, v200
    v_sub_f32 v82, v82, v200
    v_sub_f32 v83, v83, v200
    v_sub_f32 v84, v84, v200
    v_sub_f32 v85, v85, v200
    v_sub_f32 v86, v86, v200
    v_sub_f32 v87, v87, v200
    v_sub_f32 v88, v88, v200
    v_sub_f32 v89, v89, v200
    v_sub_f32 v90, v90, v200
    v_sub_f32 v91, v91, v200
    v_sub_f32 v92, v92, v200
    v_sub_f32 v93, v93, v200
    v_sub_f32 v94, v94, v200
    v_sub_f32 v95, v95, v200
    v_exp_f32 v80, v80
    v_exp_f32 v81, v81
    v_exp_f32 v82, v82
    v_exp_f32 v83, v83
    v_exp_f32 v84, v84
    v_exp_f32 v85, v85
    v_exp_f32 v86, v86
    v_exp_f32 v87, v87
    v_exp_f32 v88, v88
    v_exp_f32 v89, v89
    v_exp_f32 v90, v90
    v_exp_f32 v91, v91
    v_exp_f32 v92, v92
    v_exp_f32 v93, v93
    v_exp_f32 v94, v94
    v_exp_f32 v95, v95
    s_nop 1
    v_smfmac_f32_32x32x32_bf16 v[64:79], v[160:163], v[80:87], v8
    v_smfmac_f32_32x32x32_bf16 v[64:79], v[164:167], v[88:95], v8
    s_nop 15
    s_add_u32 s98, s98, 4096
    s_addc_u32 s99, s99, 0
    s_sub_u32 s45, s45, 1
    s_cmp_lg_u32 s45, 0
    s_cbranch_scc1 L_spv_65
    v_cndmask_b32 v73, v72, v200, s[96:97]
    ds_write_b128 v10, v[64:67] offset:2304
    ds_write_b128 v10, v[68:71] offset:3328
    ds_write_b32 v11, v73 offset:4352
    v_mov_b32 v5, 106392
    v_add_u32 v5, s44, v5
    v_mov_b32 v6, 1
    s_mov_b64 exec, 1
    ds_add_u32 v5, v6
    s_mov_b64 exec, -1
    v_mov_b32 v5, 106392
    s_mov_b32 s37, 65536
    v_add_u32 v5, s44, v5
L_ldsw_66:
    ds_read_b32 v6, v5
    s_waitcnt lgkmcnt(0)
    v_readfirstlane_b32 s32, v6
    s_nop 3
    s_cmp_ge_u32 s32, 2
    s_cbranch_scc1 L_ldsd_67
    s_sub_u32 s37, s37, 1
    s_cmp_eq_u32 s37, 0
    s_cbranch_scc1 recurrent_scan__grouped_kv_mqa__swiglu_ffn__prompt_kernel_end
    s_branch L_ldsw_66
L_ldsd_67:
    v_lshlrev_b32 v7, 2, v1
    v_sub_u32 v6, v13, v7
    v_and_b32 v7, 31, v1
    v_lshlrev_b32 v7, 2, v7
    v_add_u32 v7, v6, v7
    ds_read_b128 v[48:51], v12 offset:0
    ds_read_b128 v[52:55], v12 offset:1024
    ds_read_b32 v56, v7 offset:2048
    ds_read_b32 v57, v7 offset:2176
    ds_read_b128 v[64:67], v12 offset:2304
    ds_read_b128 v[68:71], v12 offset:3328
    ds_read_b32 v72, v7 offset:4352
    ds_read_b32 v73, v7 offset:4480
    s_waitcnt lgkmcnt(0)
    v_max_f32 v200, v25, v57
    v_sub_f32 v25, v25, v200
    v_sub_f32 v57, v57, v200
    v_exp_f32 v25, v25
    v_exp_f32 v57, v57
    s_nop 0
    v_mul_f32 v16, v16, v25
    v_fma_f32 v16, v48, v57, v16
    v_mul_f32 v17, v17, v25
    v_fma_f32 v17, v49, v57, v17
    v_mul_f32 v18, v18, v25
    v_fma_f32 v18, v50, v57, v18
    v_mul_f32 v19, v19, v25
    v_fma_f32 v19, v51, v57, v19
    v_mul_f32 v20, v20, v25
    v_fma_f32 v20, v52, v57, v20
    v_mul_f32 v21, v21, v25
    v_fma_f32 v21, v53, v57, v21
    v_mul_f32 v22, v22, v25
    v_fma_f32 v22, v54, v57, v22
    v_mul_f32 v23, v23, v25
    v_fma_f32 v23, v55, v57, v23
    v_mul_f32 v24, v24, v25
    v_fma_f32 v24, v56, v57, v24
    v_rcp_f32 v24, v24
    s_nop 0
    v_mul_f32 v16, v16, v24
    v_mul_f32 v17, v17, v24
    v_mul_f32 v18, v18, v24
    v_mul_f32 v19, v19, v24
    v_mul_f32 v20, v20, v24
    v_mul_f32 v21, v21, v24
    v_mul_f32 v22, v22, v24
    v_mul_f32 v23, v23, v24
    v_max_f32 v200, v41, v73
    v_sub_f32 v41, v41, v200
    v_sub_f32 v73, v73, v200
    v_exp_f32 v41, v41
    v_exp_f32 v73, v73
    s_nop 0
    v_mul_f32 v32, v32, v41
    v_fma_f32 v32, v64, v73, v32
    v_mul_f32 v33, v33, v41
    v_fma_f32 v33, v65, v73, v33
    v_mul_f32 v34, v34, v41
    v_fma_f32 v34, v66, v73, v34
    v_mul_f32 v35, v35, v41
    v_fma_f32 v35, v67, v73, v35
    v_mul_f32 v36, v36, v41
    v_fma_f32 v36, v68, v73, v36
    v_mul_f32 v37, v37, v41
    v_fma_f32 v37, v69, v73, v37
    v_mul_f32 v38, v38, v41
    v_fma_f32 v38, v70, v73, v38
    v_mul_f32 v39, v39, v41
    v_fma_f32 v39, v71, v73, v39
    v_mul_f32 v40, v40, v41
    v_fma_f32 v40, v72, v73, v40
    v_rcp_f32 v40, v40
    s_nop 0
    v_mul_f32 v32, v32, v40
    v_mul_f32 v33, v33, v40
    v_mul_f32 v34, v34, v40
    v_mul_f32 v35, v35, v40
    v_mul_f32 v36, v36, v40
    v_mul_f32 v37, v37, v40
    v_mul_f32 v38, v38, v40
    v_mul_f32 v39, v39, v40
    v_cvt_pk_bf16_f32 v192, v16, v17
    v_cvt_pk_bf16_f32 v193, v18, v19
    v_cvt_pk_bf16_f32 v194, v20, v21
    v_cvt_pk_bf16_f32 v195, v22, v23
    buffer_store_dwordx4 v[192:195], v2, s[8:11], s81 offen offset:0 sc1
    v_cvt_pk_bf16_f32 v196, v32, v33
    v_cvt_pk_bf16_f32 v197, v34, v35
    v_cvt_pk_bf16_f32 v198, v36, v37
    v_cvt_pk_bf16_f32 v199, v38, v39
    buffer_store_dwordx4 v[196:199], v2, s[8:11], s81 offen offset:1024 sc1
    s_waitcnt vmcnt(0)
    v_mov_b32 v5, 0
    v_mov_b32 v6, s38
    s_mov_b64 exec, 1
    buffer_store_dword v6, v5, s[8:11], s82 offen sc1
    s_mov_b64 exec, -1
    s_branch recurrent_scan__grouped_kv_mqa__swiglu_ffn__prompt_kernel_end
L_roleg_26:
    v_lshlrev_b32 v2, 4, v1
    s_mov_b32 s44, 0xbfb8aa3b
    s_lshr_b32 s47, s31, 1
    s_and_b32 s96, s31, 1
    s_cmp_eq_u32 s29, 7
    s_cbranch_scc1 L_kvunit_68
    s_setprio 0
    s_add_u32 m0, s39, 0
    s_mov_b32 s33, 0
    buffer_load_dwordx4 v4, s[16:19], s33 offen lds
    s_add_u32 m0, s39, 1024
    s_mov_b32 s33, 28672
    buffer_load_dwordx4 v4, s[16:19], s33 offen lds
    s_add_u32 m0, s39, 2048
    s_mov_b32 s33, 0
    buffer_load_dwordx4 v4, s[20:23], s33 offen lds
    s_add_u32 m0, s39, 3072
    s_mov_b32 s33, 28672
    buffer_load_dwordx4 v4, s[20:23], s33 offen lds
    s_add_u32 m0, s39, 4096
    s_mov_b32 s33, 57344
    buffer_load_dwordx4 v4, s[16:19], s33 offen lds
    s_add_u32 m0, s39, 5120
    s_mov_b32 s33, 86016
    buffer_load_dwordx4 v4, s[16:19], s33 offen lds
    s_add_u32 m0, s39, 6144
    s_mov_b32 s33, 57344
    buffer_load_dwordx4 v4, s[20:23], s33 offen lds
    s_add_u32 m0, s39, 7168
    s_mov_b32 s33, 86016
    buffer_load_dwordx4 v4, s[20:23], s33 offen lds
    s_waitcnt vmcnt(4)
    ds_read_b128 v[96:99], v7 offset:0
    ds_read_b64_tr_b16 v[64:65], v5 offset:0
    ds_read_b64_tr_b16 v[66:67], v5 offset:512
    ds_read_b64_tr_b16 v[68:69], v6 offset:0
    ds_read_b64_tr_b16 v[70:71], v6 offset:512
    ds_read_b128 v[100:103], v122 offset:0
    ds_read_b64_tr_b16 v[72:73], v5 offset:2048
    ds_read_b64_tr_b16 v[74:75], v5 offset:2560
    ds_read_b64_tr_b16 v[76:77], v6 offset:2048
    ds_read_b64_tr_b16 v[78:79], v6 offset:2560
    s_waitcnt lgkmcnt(0)
    v_mfma_f32_32x32x16_bf16 v[128:143], v[64:67], v[96:99], 0
    s_add_u32 m0, s39, 8192
    s_mov_b32 s33, 114688
    buffer_load_dwordx4 v4, s[16:19], s33 offen lds
    s_add_u32 m0, s39, 9216
    s_mov_b32 s33, 143360
    buffer_load_dwordx4 v4, s[16:19], s33 offen lds
    v_mfma_f32_32x32x16_bf16 v[144:159], v[64:67], v[100:103], 0
    s_waitcnt vmcnt(2)
    ds_read_b128 v[104:107], v7 offset:1056
    ds_read_b64_tr_b16 v[80:81], v5 offset:4096
    ds_read_b64_tr_b16 v[82:83], v5 offset:4608
    v_mfma_f32_32x32x16_bf16 v[192:207], v[72:75], v[96:99], 0
    ds_read_b64_tr_b16 v[84:85], v6 offset:4096
    ds_read_b64_tr_b16 v[86:87], v6 offset:4608
    ds_read_b128 v[108:111], v122 offset:1056
    v_mfma_f32_32x32x16_bf16 v[208:223], v[72:75], v[100:103], 0
    ds_read_b64_tr_b16 v[88:89], v5 offset:6144
    ds_read_b64_tr_b16 v[90:91], v5 offset:6656
    s_add_u32 m0, s39, 10240
    s_mov_b32 s33, 114688
    buffer_load_dwordx4 v4, s[20:23], s33 offen lds
    v_mfma_f32_32x32x16_bf16 v[160:175], v[68:71], v[96:99], 0
    ds_read_b64_tr_b16 v[92:93], v6 offset:6144
    ds_read_b64_tr_b16 v[94:95], v6 offset:6656
    s_add_u32 m0, s39, 11264
    s_mov_b32 s33, 143360
    buffer_load_dwordx4 v4, s[20:23], s33 offen lds
    v_mfma_f32_32x32x16_bf16 v[176:191], v[68:71], v[100:103], 0
    s_add_u32 m0, s39, 12288
    s_mov_b32 s33, 172032
    buffer_load_dwordx4 v4, s[16:19], s33 offen lds
    v_mfma_f32_32x32x16_bf16 v[224:239], v[76:79], v[96:99], 0
    s_add_u32 m0, s39, 13312
    s_mov_b32 s33, 200704
    buffer_load_dwordx4 v4, s[16:19], s33 offen lds
    v_mfma_f32_32x32x16_bf16 v[240:255], v[76:79], v[100:103], 0
    s_add_u32 m0, s39, 0
    s_mov_b32 s33, 172032
    buffer_load_dwordx4 v4, s[20:23], s33 offen lds
    s_add_u32 m0, s39, 1024
    s_mov_b32 s33, 200704
    buffer_load_dwordx4 v4, s[20:23], s33 offen lds
    s_add_u32 m0, s39, 2048
    s_mov_b32 s33, 229376
    buffer_load_dwordx4 v4, s[16:19], s33 offen lds
    s_add_u32 m0, s39, 3072
    s_mov_b32 s33, 258048
    buffer_load_dwordx4 v4, s[16:19], s33 offen lds
    s_waitcnt lgkmcnt(0)
    v_mfma_f32_32x32x16_bf16 v[128:143], v[80:83], v[104:107], v[128:143]
    s_add_u32 m0, s39, 4096
    s_mov_b32 s33, 229376
    buffer_load_dwordx4 v4, s[20:23], s33 offen lds
    v_mfma_f32_32x32x16_bf16 v[144:159], v[80:83], v[108:111], v[144:159]
    s_waitcnt vmcnt(7)
    ds_read_b128 v[96:99], v7 offset:2112
    ds_read_b64_tr_b16 v[64:65], v5 offset:8192
    ds_read_b64_tr_b16 v[66:67], v5 offset:8704
    v_mfma_f32_32x32x16_bf16 v[192:207], v[88:91], v[104:107], v[192:207]
    ds_read_b64_tr_b16 v[68:69], v6 offset:8192
    ds_read_b64_tr_b16 v[70:71], v6 offset:8704
    ds_read_b128 v[100:103], v122 offset:2112
    v_mfma_f32_32x32x16_bf16 v[208:223], v[88:91], v[108:111], v[208:223]
    ds_read_b64_tr_b16 v[72:73], v5 offset:10240
    ds_read_b64_tr_b16 v[74:75], v5 offset:10752
    v_mfma_f32_32x32x16_bf16 v[160:175], v[84:87], v[104:107], v[160:175]
    ds_read_b64_tr_b16 v[76:77], v6 offset:10240
    ds_read_b64_tr_b16 v[78:79], v6 offset:10752
    v_mfma_f32_32x32x16_bf16 v[176:191], v[84:87], v[108:111], v[176:191]
    s_add_u32 m0, s39, 5120
    s_mov_b32 s33, 258048
    buffer_load_dwordx4 v4, s[20:23], s33 offen lds
    v_mfma_f32_32x32x16_bf16 v[224:239], v[92:95], v[104:107], v[224:239]
    s_add_u32 m0, s39, 6144
    s_mov_b32 s33, 286720
    buffer_load_dwordx4 v4, s[16:19], s33 offen lds
    v_mfma_f32_32x32x16_bf16 v[240:255], v[92:95], v[108:111], v[240:255]
    s_add_u32 m0, s39, 7168
    s_mov_b32 s33, 315392
    buffer_load_dwordx4 v4, s[16:19], s33 offen lds
    s_waitcnt lgkmcnt(0)
    v_mfma_f32_32x32x16_bf16 v[128:143], v[64:67], v[96:99], v[128:143]
    s_add_u32 m0, s39, 8192
    s_mov_b32 s33, 286720
    buffer_load_dwordx4 v4, s[20:23], s33 offen lds
    v_mfma_f32_32x32x16_bf16 v[144:159], v[64:67], v[100:103], v[144:159]
    s_waitcnt vmcnt(7)
    ds_read_b128 v[104:107], v7 offset:3168
    ds_read_b64_tr_b16 v[80:81], v5 offset:12288
    ds_read_b64_tr_b16 v[82:83], v5 offset:12800
    v_mfma_f32_32x32x16_bf16 v[192:207], v[72:75], v[96:99], v[192:207]
    ds_read_b64_tr_b16 v[84:85], v6 offset:12288
    ds_read_b64_tr_b16 v[86:87], v6 offset:12800
    ds_read_b128 v[108:111], v122 offset:3168
    v_mfma_f32_32x32x16_bf16 v[208:223], v[72:75], v[100:103], v[208:223]
    ds_read_b64_tr_b16 v[88:89], v5 offset:0
    ds_read_b64_tr_b16 v[90:91], v5 offset:512
    v_mfma_f32_32x32x16_bf16 v[160:175], v[68:71], v[96:99], v[160:175]
    ds_read_b64_tr_b16 v[92:93], v6 offset:0
    ds_read_b64_tr_b16 v[94:95], v6 offset:512
    v_mfma_f32_32x32x16_bf16 v[176:191], v[68:71], v[100:103], v[176:191]
    s_add_u32 m0, s39, 9216
    s_mov_b32 s33, 315392
    buffer_load_dwordx4 v4, s[20:23], s33 offen lds
    v_mfma_f32_32x32x16_bf16 v[224:239], v[76:79], v[96:99], v[224:239]
    s_add_u32 m0, s39, 10240
    s_mov_b32 s33, 344064
    buffer_load_dwordx4 v4, s[16:19], s33 offen lds
    v_mfma_f32_32x32x16_bf16 v[240:255], v[76:79], v[100:103], v[240:255]
    s_add_u32 m0, s39, 11264
    s_mov_b32 s33, 372736
    buffer_load_dwordx4 v4, s[16:19], s33 offen lds
    s_waitcnt lgkmcnt(0)
    v_mfma_f32_32x32x16_bf16 v[128:143], v[80:83], v[104:107], v[128:143]
    s_add_u32 m0, s39, 12288
    s_mov_b32 s33, 344064
    buffer_load_dwordx4 v4, s[20:23], s33 offen lds
    v_mfma_f32_32x32x16_bf16 v[144:159], v[80:83], v[108:111], v[144:159]
    s_waitcnt vmcnt(7)
    ds_read_b128 v[96:99], v7 offset:4224
    ds_read_b64_tr_b16 v[64:65], v5 offset:2048
    ds_read_b64_tr_b16 v[66:67], v5 offset:2560
    v_mfma_f32_32x32x16_bf16 v[192:207], v[88:91], v[104:107], v[192:207]
    ds_read_b64_tr_b16 v[68:69], v6 offset:2048
    ds_read_b64_tr_b16 v[70:71], v6 offset:2560
    ds_read_b128 v[100:103], v122 offset:4224
    v_mfma_f32_32x32x16_bf16 v[208:223], v[88:91], v[108:111], v[208:223]
    ds_read_b64_tr_b16 v[72:73], v5 offset:4096
    ds_read_b64_tr_b16 v[74:75], v5 offset:4608
    v_mfma_f32_32x32x16_bf16 v[160:175], v[84:87], v[104:107], v[160:175]
    ds_read_b64_tr_b16 v[76:77], v6 offset:4096
    ds_read_b64_tr_b16 v[78:79], v6 offset:4608
    v_mfma_f32_32x32x16_bf16 v[176:191], v[84:87], v[108:111], v[176:191]
    s_add_u32 m0, s39, 13312
    s_mov_b32 s33, 372736
    buffer_load_dwordx4 v4, s[20:23], s33 offen lds
    v_mfma_f32_32x32x16_bf16 v[224:239], v[92:95], v[104:107], v[224:239]
    s_add_u32 m0, s39, 0
    s_mov_b32 s33, 401408
    buffer_load_dwordx4 v4, s[16:19], s33 offen lds
    v_mfma_f32_32x32x16_bf16 v[240:255], v[92:95], v[108:111], v[240:255]
    s_add_u32 m0, s39, 1024
    s_mov_b32 s33, 430080
    buffer_load_dwordx4 v4, s[16:19], s33 offen lds
    s_waitcnt lgkmcnt(0)
    v_mfma_f32_32x32x16_bf16 v[128:143], v[64:67], v[96:99], v[128:143]
    s_add_u32 m0, s39, 2048
    s_mov_b32 s33, 401408
    buffer_load_dwordx4 v4, s[20:23], s33 offen lds
    v_mfma_f32_32x32x16_bf16 v[144:159], v[64:67], v[100:103], v[144:159]
    s_waitcnt vmcnt(7)
    ds_read_b128 v[104:107], v7 offset:5280
    ds_read_b64_tr_b16 v[80:81], v5 offset:6144
    ds_read_b64_tr_b16 v[82:83], v5 offset:6656
    v_mfma_f32_32x32x16_bf16 v[192:207], v[72:75], v[96:99], v[192:207]
    ds_read_b64_tr_b16 v[84:85], v6 offset:6144
    ds_read_b64_tr_b16 v[86:87], v6 offset:6656
    ds_read_b128 v[108:111], v122 offset:5280
    v_mfma_f32_32x32x16_bf16 v[208:223], v[72:75], v[100:103], v[208:223]
    ds_read_b64_tr_b16 v[88:89], v5 offset:8192
    ds_read_b64_tr_b16 v[90:91], v5 offset:8704
    v_mfma_f32_32x32x16_bf16 v[160:175], v[68:71], v[96:99], v[160:175]
    ds_read_b64_tr_b16 v[92:93], v6 offset:8192
    ds_read_b64_tr_b16 v[94:95], v6 offset:8704
    v_mfma_f32_32x32x16_bf16 v[176:191], v[68:71], v[100:103], v[176:191]
    s_add_u32 m0, s39, 3072
    s_mov_b32 s33, 430080
    buffer_load_dwordx4 v4, s[20:23], s33 offen lds
    v_mfma_f32_32x32x16_bf16 v[224:239], v[76:79], v[96:99], v[224:239]
    s_add_u32 m0, s39, 4096
    s_mov_b32 s33, 458752
    buffer_load_dwordx4 v4, s[16:19], s33 offen lds
    v_mfma_f32_32x32x16_bf16 v[240:255], v[76:79], v[100:103], v[240:255]
    s_add_u32 m0, s39, 5120
    s_mov_b32 s33, 487424
    buffer_load_dwordx4 v4, s[16:19], s33 offen lds
    s_waitcnt lgkmcnt(0)
    v_mfma_f32_32x32x16_bf16 v[128:143], v[80:83], v[104:107], v[128:143]
    s_add_u32 m0, s39, 6144
    s_mov_b32 s33, 458752
    buffer_load_dwordx4 v4, s[20:23], s33 offen lds
    v_mfma_f32_32x32x16_bf16 v[144:159], v[80:83], v[108:111], v[144:159]
    s_waitcnt vmcnt(7)
    ds_read_b128 v[96:99], v7 offset:6336
    ds_read_b64_tr_b16 v[64:65], v5 offset:10240
    ds_read_b64_tr_b16 v[66:67], v5 offset:10752
    v_mfma_f32_32x32x16_bf16 v[192:207], v[88:91], v[104:107], v[192:207]
    ds_read_b64_tr_b16 v[68:69], v6 offset:10240
    ds_read_b64_tr_b16 v[70:71], v6 offset:10752
    ds_read_b128 v[100:103], v122 offset:6336
    v_mfma_f32_32x32x16_bf16 v[208:223], v[88:91], v[108:111], v[208:223]
    ds_read_b64_tr_b16 v[72:73], v5 offset:12288
    ds_read_b64_tr_b16 v[74:75], v5 offset:12800
    v_mfma_f32_32x32x16_bf16 v[160:175], v[84:87], v[104:107], v[160:175]
    ds_read_b64_tr_b16 v[76:77], v6 offset:12288
    ds_read_b64_tr_b16 v[78:79], v6 offset:12800
    v_mfma_f32_32x32x16_bf16 v[176:191], v[84:87], v[108:111], v[176:191]
    s_add_u32 m0, s39, 7168
    s_mov_b32 s33, 487424
    buffer_load_dwordx4 v4, s[20:23], s33 offen lds
    v_mfma_f32_32x32x16_bf16 v[224:239], v[92:95], v[104:107], v[224:239]
    s_add_u32 m0, s39, 8192
    s_mov_b32 s33, 516096
    buffer_load_dwordx4 v4, s[16:19], s33 offen lds
    v_mfma_f32_32x32x16_bf16 v[240:255], v[92:95], v[108:111], v[240:255]
    s_add_u32 m0, s39, 9216
    s_mov_b32 s33, 544768
    buffer_load_dwordx4 v4, s[16:19], s33 offen lds
    s_waitcnt lgkmcnt(0)
    v_mfma_f32_32x32x16_bf16 v[128:143], v[64:67], v[96:99], v[128:143]
    s_add_u32 m0, s39, 10240
    s_mov_b32 s33, 516096
    buffer_load_dwordx4 v4, s[20:23], s33 offen lds
    v_mfma_f32_32x32x16_bf16 v[144:159], v[64:67], v[100:103], v[144:159]
    s_waitcnt vmcnt(7)
    ds_read_b128 v[104:107], v7 offset:7392
    ds_read_b64_tr_b16 v[80:81], v5 offset:0
    ds_read_b64_tr_b16 v[82:83], v5 offset:512
    v_mfma_f32_32x32x16_bf16 v[192:207], v[72:75], v[96:99], v[192:207]
    ds_read_b64_tr_b16 v[84:85], v6 offset:0
    ds_read_b64_tr_b16 v[86:87], v6 offset:512
    ds_read_b128 v[108:111], v122 offset:7392
    v_mfma_f32_32x32x16_bf16 v[208:223], v[72:75], v[100:103], v[208:223]
    ds_read_b64_tr_b16 v[88:89], v5 offset:2048
    ds_read_b64_tr_b16 v[90:91], v5 offset:2560
    v_mfma_f32_32x32x16_bf16 v[160:175], v[68:71], v[96:99], v[160:175]
    ds_read_b64_tr_b16 v[92:93], v6 offset:2048
    ds_read_b64_tr_b16 v[94:95], v6 offset:2560
    v_mfma_f32_32x32x16_bf16 v[176:191], v[68:71], v[100:103], v[176:191]
    s_add_u32 m0, s39, 11264
    s_mov_b32 s33, 544768
    buffer_load_dwordx4 v4, s[20:23], s33 offen lds
    v_mfma_f32_32x32x16_bf16 v[224:239], v[76:79], v[96:99], v[224:239]
    s_add_u32 m0, s39, 12288
    s_mov_b32 s33, 573440
    buffer_load_dwordx4 v4, s[16:19], s33 offen lds
    v_mfma_f32_32x32x16_bf16 v[240:255], v[76:79], v[100:103], v[240:255]
    s_add_u32 m0, s39, 13312
    s_mov_b32 s33, 602112
    buffer_load_dwordx4 v4, s[16:19], s33 offen lds
    s_waitcnt lgkmcnt(0)
    v_mfma_f32_32x32x16_bf16 v[128:143], v[80:83], v[104:107], v[128:143]
    s_add_u32 m0, s39, 0
    s_mov_b32 s33, 573440
    buffer_load_dwordx4 v4, s[20:23], s33 offen lds
    v_mfma_f32_32x32x16_bf16 v[144:159], v[80:83], v[108:111], v[144:159]
    s_waitcnt vmcnt(7)
    ds_read_b128 v[96:99], v7 offset:8448
    ds_read_b64_tr_b16 v[64:65], v5 offset:4096
    ds_read_b64_tr_b16 v[66:67], v5 offset:4608
    v_mfma_f32_32x32x16_bf16 v[192:207], v[88:91], v[104:107], v[192:207]
    ds_read_b64_tr_b16 v[68:69], v6 offset:4096
    ds_read_b64_tr_b16 v[70:71], v6 offset:4608
    ds_read_b128 v[100:103], v122 offset:8448
    v_mfma_f32_32x32x16_bf16 v[208:223], v[88:91], v[108:111], v[208:223]
    ds_read_b64_tr_b16 v[72:73], v5 offset:6144
    ds_read_b64_tr_b16 v[74:75], v5 offset:6656
    v_mfma_f32_32x32x16_bf16 v[160:175], v[84:87], v[104:107], v[160:175]
    ds_read_b64_tr_b16 v[76:77], v6 offset:6144
    ds_read_b64_tr_b16 v[78:79], v6 offset:6656
    v_mfma_f32_32x32x16_bf16 v[176:191], v[84:87], v[108:111], v[176:191]
    s_add_u32 m0, s39, 1024
    s_mov_b32 s33, 602112
    buffer_load_dwordx4 v4, s[20:23], s33 offen lds
    v_mfma_f32_32x32x16_bf16 v[224:239], v[92:95], v[104:107], v[224:239]
    s_add_u32 m0, s39, 2048
    s_mov_b32 s33, 630784
    buffer_load_dwordx4 v4, s[16:19], s33 offen lds
    v_mfma_f32_32x32x16_bf16 v[240:255], v[92:95], v[108:111], v[240:255]
    s_add_u32 m0, s39, 3072
    s_mov_b32 s33, 659456
    buffer_load_dwordx4 v4, s[16:19], s33 offen lds
    s_waitcnt lgkmcnt(0)
    v_mfma_f32_32x32x16_bf16 v[128:143], v[64:67], v[96:99], v[128:143]
    s_add_u32 m0, s39, 4096
    s_mov_b32 s33, 630784
    buffer_load_dwordx4 v4, s[20:23], s33 offen lds
    v_mfma_f32_32x32x16_bf16 v[144:159], v[64:67], v[100:103], v[144:159]
    s_waitcnt vmcnt(7)
    ds_read_b128 v[104:107], v7 offset:9504
    ds_read_b64_tr_b16 v[80:81], v5 offset:8192
    ds_read_b64_tr_b16 v[82:83], v5 offset:8704
    v_mfma_f32_32x32x16_bf16 v[192:207], v[72:75], v[96:99], v[192:207]
    ds_read_b64_tr_b16 v[84:85], v6 offset:8192
    ds_read_b64_tr_b16 v[86:87], v6 offset:8704
    ds_read_b128 v[108:111], v122 offset:9504
    v_mfma_f32_32x32x16_bf16 v[208:223], v[72:75], v[100:103], v[208:223]
    ds_read_b64_tr_b16 v[88:89], v5 offset:10240
    ds_read_b64_tr_b16 v[90:91], v5 offset:10752
    v_mfma_f32_32x32x16_bf16 v[160:175], v[68:71], v[96:99], v[160:175]
    ds_read_b64_tr_b16 v[92:93], v6 offset:10240
    ds_read_b64_tr_b16 v[94:95], v6 offset:10752
    v_mfma_f32_32x32x16_bf16 v[176:191], v[68:71], v[100:103], v[176:191]
    s_add_u32 m0, s39, 5120
    s_mov_b32 s33, 659456
    buffer_load_dwordx4 v4, s[20:23], s33 offen lds
    v_mfma_f32_32x32x16_bf16 v[224:239], v[76:79], v[96:99], v[224:239]
    s_add_u32 m0, s39, 6144
    s_mov_b32 s33, 688128
    buffer_load_dwordx4 v4, s[16:19], s33 offen lds
    v_mfma_f32_32x32x16_bf16 v[240:255], v[76:79], v[100:103], v[240:255]
    s_add_u32 m0, s39, 7168
    s_mov_b32 s33, 716800
    buffer_load_dwordx4 v4, s[16:19], s33 offen lds
    s_waitcnt lgkmcnt(0)
    v_mfma_f32_32x32x16_bf16 v[128:143], v[80:83], v[104:107], v[128:143]
    s_add_u32 m0, s39, 8192
    s_mov_b32 s33, 688128
    buffer_load_dwordx4 v4, s[20:23], s33 offen lds
    v_mfma_f32_32x32x16_bf16 v[144:159], v[80:83], v[108:111], v[144:159]
    s_waitcnt vmcnt(7)
    ds_read_b128 v[96:99], v7 offset:10560
    ds_read_b64_tr_b16 v[64:65], v5 offset:12288
    ds_read_b64_tr_b16 v[66:67], v5 offset:12800
    v_mfma_f32_32x32x16_bf16 v[192:207], v[88:91], v[104:107], v[192:207]
    ds_read_b64_tr_b16 v[68:69], v6 offset:12288
    ds_read_b64_tr_b16 v[70:71], v6 offset:12800
    ds_read_b128 v[100:103], v122 offset:10560
    v_mfma_f32_32x32x16_bf16 v[208:223], v[88:91], v[108:111], v[208:223]
    ds_read_b64_tr_b16 v[72:73], v5 offset:0
    ds_read_b64_tr_b16 v[74:75], v5 offset:512
    v_mfma_f32_32x32x16_bf16 v[160:175], v[84:87], v[104:107], v[160:175]
    ds_read_b64_tr_b16 v[76:77], v6 offset:0
    ds_read_b64_tr_b16 v[78:79], v6 offset:512
    v_mfma_f32_32x32x16_bf16 v[176:191], v[84:87], v[108:111], v[176:191]
    s_add_u32 m0, s39, 9216
    s_mov_b32 s33, 716800
    buffer_load_dwordx4 v4, s[20:23], s33 offen lds
    v_mfma_f32_32x32x16_bf16 v[224:239], v[92:95], v[104:107], v[224:239]
    s_add_u32 m0, s39, 10240
    s_mov_b32 s33, 745472
    buffer_load_dwordx4 v4, s[16:19], s33 offen lds
    v_mfma_f32_32x32x16_bf16 v[240:255], v[92:95], v[108:111], v[240:255]
    s_add_u32 m0, s39, 11264
    s_mov_b32 s33, 774144
    buffer_load_dwordx4 v4, s[16:19], s33 offen lds
    s_waitcnt lgkmcnt(0)
    v_mfma_f32_32x32x16_bf16 v[128:143], v[64:67], v[96:99], v[128:143]
    s_add_u32 m0, s39, 12288
    s_mov_b32 s33, 745472
    buffer_load_dwordx4 v4, s[20:23], s33 offen lds
    v_mfma_f32_32x32x16_bf16 v[144:159], v[64:67], v[100:103], v[144:159]
    s_waitcnt vmcnt(7)
    ds_read_b128 v[104:107], v7 offset:11616
    ds_read_b64_tr_b16 v[80:81], v5 offset:2048
    ds_read_b64_tr_b16 v[82:83], v5 offset:2560
    v_mfma_f32_32x32x16_bf16 v[192:207], v[72:75], v[96:99], v[192:207]
    ds_read_b64_tr_b16 v[84:85], v6 offset:2048
    ds_read_b64_tr_b16 v[86:87], v6 offset:2560
    ds_read_b128 v[108:111], v122 offset:11616
    v_mfma_f32_32x32x16_bf16 v[208:223], v[72:75], v[100:103], v[208:223]
    ds_read_b64_tr_b16 v[88:89], v5 offset:4096
    ds_read_b64_tr_b16 v[90:91], v5 offset:4608
    v_mfma_f32_32x32x16_bf16 v[160:175], v[68:71], v[96:99], v[160:175]
    ds_read_b64_tr_b16 v[92:93], v6 offset:4096
    ds_read_b64_tr_b16 v[94:95], v6 offset:4608
    v_mfma_f32_32x32x16_bf16 v[176:191], v[68:71], v[100:103], v[176:191]
    s_add_u32 m0, s39, 13312
    s_mov_b32 s33, 774144
    buffer_load_dwordx4 v4, s[20:23], s33 offen lds
    v_mfma_f32_32x32x16_bf16 v[224:239], v[76:79], v[96:99], v[224:239]
    s_add_u32 m0, s39, 0
    s_mov_b32 s33, 802816
    buffer_load_dwordx4 v4, s[16:19], s33 offen lds
    v_mfma_f32_32x32x16_bf16 v[240:255], v[76:79], v[100:103], v[240:255]
    s_add_u32 m0, s39, 1024
    s_mov_b32 s33, 831488
    buffer_load_dwordx4 v4, s[16:19], s33 offen lds
    s_waitcnt lgkmcnt(0)
    v_mfma_f32_32x32x16_bf16 v[128:143], v[80:83], v[104:107], v[128:143]
    s_add_u32 m0, s39, 2048
    s_mov_b32 s33, 802816
    buffer_load_dwordx4 v4, s[20:23], s33 offen lds
    v_mfma_f32_32x32x16_bf16 v[144:159], v[80:83], v[108:111], v[144:159]
    s_waitcnt vmcnt(7)
    ds_read_b128 v[96:99], v7 offset:12672
    ds_read_b64_tr_b16 v[64:65], v5 offset:6144
    ds_read_b64_tr_b16 v[66:67], v5 offset:6656
    v_mfma_f32_32x32x16_bf16 v[192:207], v[88:91], v[104:107], v[192:207]
    ds_read_b64_tr_b16 v[68:69], v6 offset:6144
    ds_read_b64_tr_b16 v[70:71], v6 offset:6656
    ds_read_b128 v[100:103], v122 offset:12672
    v_mfma_f32_32x32x16_bf16 v[208:223], v[88:91], v[108:111], v[208:223]
    ds_read_b64_tr_b16 v[72:73], v5 offset:8192
    ds_read_b64_tr_b16 v[74:75], v5 offset:8704
    v_mfma_f32_32x32x16_bf16 v[160:175], v[84:87], v[104:107], v[160:175]
    ds_read_b64_tr_b16 v[76:77], v6 offset:8192
    ds_read_b64_tr_b16 v[78:79], v6 offset:8704
    v_mfma_f32_32x32x16_bf16 v[176:191], v[84:87], v[108:111], v[176:191]
    s_add_u32 m0, s39, 3072
    s_mov_b32 s33, 831488
    buffer_load_dwordx4 v4, s[20:23], s33 offen lds
    v_mfma_f32_32x32x16_bf16 v[224:239], v[92:95], v[104:107], v[224:239]
    s_add_u32 m0, s39, 4096
    s_mov_b32 s33, 860160
    buffer_load_dwordx4 v4, s[16:19], s33 offen lds
    v_mfma_f32_32x32x16_bf16 v[240:255], v[92:95], v[108:111], v[240:255]
    s_add_u32 m0, s39, 5120
    s_mov_b32 s33, 888832
    buffer_load_dwordx4 v4, s[16:19], s33 offen lds
    s_waitcnt lgkmcnt(0)
    v_mfma_f32_32x32x16_bf16 v[128:143], v[64:67], v[96:99], v[128:143]
    s_add_u32 m0, s39, 6144
    s_mov_b32 s33, 860160
    buffer_load_dwordx4 v4, s[20:23], s33 offen lds
    v_mfma_f32_32x32x16_bf16 v[144:159], v[64:67], v[100:103], v[144:159]
    s_waitcnt vmcnt(7)
    ds_read_b128 v[104:107], v7 offset:13728
    ds_read_b64_tr_b16 v[80:81], v5 offset:10240
    ds_read_b64_tr_b16 v[82:83], v5 offset:10752
    v_mfma_f32_32x32x16_bf16 v[192:207], v[72:75], v[96:99], v[192:207]
    ds_read_b64_tr_b16 v[84:85], v6 offset:10240
    ds_read_b64_tr_b16 v[86:87], v6 offset:10752
    ds_read_b128 v[108:111], v122 offset:13728
    v_mfma_f32_32x32x16_bf16 v[208:223], v[72:75], v[100:103], v[208:223]
    ds_read_b64_tr_b16 v[88:89], v5 offset:12288
    ds_read_b64_tr_b16 v[90:91], v5 offset:12800
    v_mfma_f32_32x32x16_bf16 v[160:175], v[68:71], v[96:99], v[160:175]
    ds_read_b64_tr_b16 v[92:93], v6 offset:12288
    ds_read_b64_tr_b16 v[94:95], v6 offset:12800
    v_mfma_f32_32x32x16_bf16 v[176:191], v[68:71], v[100:103], v[176:191]
    s_add_u32 m0, s39, 7168
    s_mov_b32 s33, 888832
    buffer_load_dwordx4 v4, s[20:23], s33 offen lds
    v_mfma_f32_32x32x16_bf16 v[224:239], v[76:79], v[96:99], v[224:239]
    s_add_u32 m0, s39, 8192
    s_mov_b32 s33, 917504
    buffer_load_dwordx4 v4, s[16:19], s33 offen lds
    v_mfma_f32_32x32x16_bf16 v[240:255], v[76:79], v[100:103], v[240:255]
    s_add_u32 m0, s39, 9216
    s_mov_b32 s33, 946176
    buffer_load_dwordx4 v4, s[16:19], s33 offen lds
    s_waitcnt lgkmcnt(0)
    v_mfma_f32_32x32x16_bf16 v[128:143], v[80:83], v[104:107], v[128:143]
    s_add_u32 m0, s39, 10240
    s_mov_b32 s33, 917504
    buffer_load_dwordx4 v4, s[20:23], s33 offen lds
    v_mfma_f32_32x32x16_bf16 v[144:159], v[80:83], v[108:111], v[144:159]
    s_waitcnt vmcnt(7)
    ds_read_b128 v[96:99], v7 offset:14784
    ds_read_b64_tr_b16 v[64:65], v5 offset:0
    ds_read_b64_tr_b16 v[66:67], v5 offset:512
    v_mfma_f32_32x32x16_bf16 v[192:207], v[88:91], v[104:107], v[192:207]
    ds_read_b64_tr_b16 v[68:69], v6 offset:0
    ds_read_b64_tr_b16 v[70:71], v6 offset:512
    ds_read_b128 v[100:103], v122 offset:14784
    v_mfma_f32_32x32x16_bf16 v[208:223], v[88:91], v[108:111], v[208:223]
    ds_read_b64_tr_b16 v[72:73], v5 offset:2048
    ds_read_b64_tr_b16 v[74:75], v5 offset:2560
    v_mfma_f32_32x32x16_bf16 v[160:175], v[84:87], v[104:107], v[160:175]
    ds_read_b64_tr_b16 v[76:77], v6 offset:2048
    ds_read_b64_tr_b16 v[78:79], v6 offset:2560
    v_mfma_f32_32x32x16_bf16 v[176:191], v[84:87], v[108:111], v[176:191]
    s_add_u32 m0, s39, 11264
    s_mov_b32 s33, 946176
    buffer_load_dwordx4 v4, s[20:23], s33 offen lds
    v_mfma_f32_32x32x16_bf16 v[224:239], v[92:95], v[104:107], v[224:239]
    s_add_u32 m0, s39, 12288
    s_mov_b32 s33, 974848
    buffer_load_dwordx4 v4, s[16:19], s33 offen lds
    v_mfma_f32_32x32x16_bf16 v[240:255], v[92:95], v[108:111], v[240:255]
    s_add_u32 m0, s39, 13312
    s_mov_b32 s33, 1003520
    buffer_load_dwordx4 v4, s[16:19], s33 offen lds
    s_waitcnt lgkmcnt(0)
    v_mfma_f32_32x32x16_bf16 v[128:143], v[64:67], v[96:99], v[128:143]
    s_add_u32 m0, s39, 0
    s_mov_b32 s33, 974848
    buffer_load_dwordx4 v4, s[20:23], s33 offen lds
    v_mfma_f32_32x32x16_bf16 v[144:159], v[64:67], v[100:103], v[144:159]
    s_waitcnt vmcnt(7)
    ds_read_b128 v[104:107], v7 offset:15840
    ds_read_b64_tr_b16 v[80:81], v5 offset:4096
    ds_read_b64_tr_b16 v[82:83], v5 offset:4608
    v_mfma_f32_32x32x16_bf16 v[192:207], v[72:75], v[96:99], v[192:207]
    ds_read_b64_tr_b16 v[84:85], v6 offset:4096
    ds_read_b64_tr_b16 v[86:87], v6 offset:4608
    ds_read_b128 v[108:111], v122 offset:15840
    v_mfma_f32_32x32x16_bf16 v[208:223], v[72:75], v[100:103], v[208:223]
    ds_read_b64_tr_b16 v[88:89], v5 offset:6144
    ds_read_b64_tr_b16 v[90:91], v5 offset:6656
    v_mfma_f32_32x32x16_bf16 v[160:175], v[68:71], v[96:99], v[160:175]
    ds_read_b64_tr_b16 v[92:93], v6 offset:6144
    ds_read_b64_tr_b16 v[94:95], v6 offset:6656
    v_mfma_f32_32x32x16_bf16 v[176:191], v[68:71], v[100:103], v[176:191]
    s_add_u32 m0, s39, 1024
    s_mov_b32 s33, 1003520
    buffer_load_dwordx4 v4, s[20:23], s33 offen lds
    v_mfma_f32_32x32x16_bf16 v[224:239], v[76:79], v[96:99], v[224:239]
    s_add_u32 m0, s39, 2048
    s_mov_b32 s33, 1032192
    buffer_load_dwordx4 v4, s[16:19], s33 offen lds
    v_mfma_f32_32x32x16_bf16 v[240:255], v[76:79], v[100:103], v[240:255]
    s_add_u32 m0, s39, 3072
    s_mov_b32 s33, 1060864
    buffer_load_dwordx4 v4, s[16:19], s33 offen lds
    s_waitcnt lgkmcnt(0)
    v_mfma_f32_32x32x16_bf16 v[128:143], v[80:83], v[104:107], v[128:143]
    s_add_u32 m0, s39, 4096
    s_mov_b32 s33, 1032192
    buffer_load_dwordx4 v4, s[20:23], s33 offen lds
    v_mfma_f32_32x32x16_bf16 v[144:159], v[80:83], v[108:111], v[144:159]
    s_waitcnt vmcnt(7)
    ds_read_b128 v[96:99], v7 offset:16896
    ds_read_b64_tr_b16 v[64:65], v5 offset:8192
    ds_read_b64_tr_b16 v[66:67], v5 offset:8704
    v_mfma_f32_32x32x16_bf16 v[192:207], v[88:91], v[104:107], v[192:207]
    ds_read_b64_tr_b16 v[68:69], v6 offset:8192
    ds_read_b64_tr_b16 v[70:71], v6 offset:8704
    ds_read_b128 v[100:103], v122 offset:16896
    v_mfma_f32_32x32x16_bf16 v[208:223], v[88:91], v[108:111], v[208:223]
    ds_read_b64_tr_b16 v[72:73], v5 offset:10240
    ds_read_b64_tr_b16 v[74:75], v5 offset:10752
    v_mfma_f32_32x32x16_bf16 v[160:175], v[84:87], v[104:107], v[160:175]
    ds_read_b64_tr_b16 v[76:77], v6 offset:10240
    ds_read_b64_tr_b16 v[78:79], v6 offset:10752
    v_mfma_f32_32x32x16_bf16 v[176:191], v[84:87], v[108:111], v[176:191]
    s_add_u32 m0, s39, 5120
    s_mov_b32 s33, 1060864
    buffer_load_dwordx4 v4, s[20:23], s33 offen lds
    v_mfma_f32_32x32x16_bf16 v[224:239], v[92:95], v[104:107], v[224:239]
    s_add_u32 m0, s39, 6144
    s_mov_b32 s33, 1089536
    buffer_load_dwordx4 v4, s[16:19], s33 offen lds
    v_mfma_f32_32x32x16_bf16 v[240:255], v[92:95], v[108:111], v[240:255]
    s_add_u32 m0, s39, 7168
    s_mov_b32 s33, 1118208
    buffer_load_dwordx4 v4, s[16:19], s33 offen lds
    s_waitcnt lgkmcnt(0)
    v_mfma_f32_32x32x16_bf16 v[128:143], v[64:67], v[96:99], v[128:143]
    s_add_u32 m0, s39, 8192
    s_mov_b32 s33, 1089536
    buffer_load_dwordx4 v4, s[20:23], s33 offen lds
    v_mfma_f32_32x32x16_bf16 v[144:159], v[64:67], v[100:103], v[144:159]
    s_waitcnt vmcnt(7)
    ds_read_b128 v[104:107], v7 offset:17952
    ds_read_b64_tr_b16 v[80:81], v5 offset:12288
    ds_read_b64_tr_b16 v[82:83], v5 offset:12800
    v_mfma_f32_32x32x16_bf16 v[192:207], v[72:75], v[96:99], v[192:207]
    ds_read_b64_tr_b16 v[84:85], v6 offset:12288
    ds_read_b64_tr_b16 v[86:87], v6 offset:12800
    ds_read_b128 v[108:111], v122 offset:17952
    v_mfma_f32_32x32x16_bf16 v[208:223], v[72:75], v[100:103], v[208:223]
    ds_read_b64_tr_b16 v[88:89], v5 offset:0
    ds_read_b64_tr_b16 v[90:91], v5 offset:512
    v_mfma_f32_32x32x16_bf16 v[160:175], v[68:71], v[96:99], v[160:175]
    ds_read_b64_tr_b16 v[92:93], v6 offset:0
    ds_read_b64_tr_b16 v[94:95], v6 offset:512
    v_mfma_f32_32x32x16_bf16 v[176:191], v[68:71], v[100:103], v[176:191]
    s_add_u32 m0, s39, 9216
    s_mov_b32 s33, 1118208
    buffer_load_dwordx4 v4, s[20:23], s33 offen lds
    v_mfma_f32_32x32x16_bf16 v[224:239], v[76:79], v[96:99], v[224:239]
    s_add_u32 m0, s39, 10240
    s_mov_b32 s33, 1146880
    buffer_load_dwordx4 v4, s[16:19], s33 offen lds
    v_mfma_f32_32x32x16_bf16 v[240:255], v[76:79], v[100:103], v[240:255]
    s_add_u32 m0, s39, 11264
    s_mov_b32 s33, 1175552
    buffer_load_dwordx4 v4, s[16:19], s33 offen lds
    s_waitcnt lgkmcnt(0)
    v_mfma_f32_32x32x16_bf16 v[128:143], v[80:83], v[104:107], v[128:143]
    s_add_u32 m0, s39, 12288
    s_mov_b32 s33, 1146880
    buffer_load_dwordx4 v4, s[20:23], s33 offen lds
    v_mfma_f32_32x32x16_bf16 v[144:159], v[80:83], v[108:111], v[144:159]
    s_waitcnt vmcnt(7)
    ds_read_b128 v[96:99], v7 offset:19008
    ds_read_b64_tr_b16 v[64:65], v5 offset:2048
    ds_read_b64_tr_b16 v[66:67], v5 offset:2560
    v_mfma_f32_32x32x16_bf16 v[192:207], v[88:91], v[104:107], v[192:207]
    ds_read_b64_tr_b16 v[68:69], v6 offset:2048
    ds_read_b64_tr_b16 v[70:71], v6 offset:2560
    ds_read_b128 v[100:103], v122 offset:19008
    v_mfma_f32_32x32x16_bf16 v[208:223], v[88:91], v[108:111], v[208:223]
    ds_read_b64_tr_b16 v[72:73], v5 offset:4096
    ds_read_b64_tr_b16 v[74:75], v5 offset:4608
    v_mfma_f32_32x32x16_bf16 v[160:175], v[84:87], v[104:107], v[160:175]
    ds_read_b64_tr_b16 v[76:77], v6 offset:4096
    ds_read_b64_tr_b16 v[78:79], v6 offset:4608
    v_mfma_f32_32x32x16_bf16 v[176:191], v[84:87], v[108:111], v[176:191]
    s_add_u32 m0, s39, 13312
    s_mov_b32 s33, 1175552
    buffer_load_dwordx4 v4, s[20:23], s33 offen lds
    v_mfma_f32_32x32x16_bf16 v[224:239], v[92:95], v[104:107], v[224:239]
    s_add_u32 m0, s39, 0
    s_mov_b32 s33, 1204224
    buffer_load_dwordx4 v4, s[16:19], s33 offen lds
    v_mfma_f32_32x32x16_bf16 v[240:255], v[92:95], v[108:111], v[240:255]
    s_add_u32 m0, s39, 1024
    s_mov_b32 s33, 1232896
    buffer_load_dwordx4 v4, s[16:19], s33 offen lds
    s_waitcnt lgkmcnt(0)
    v_mfma_f32_32x32x16_bf16 v[128:143], v[64:67], v[96:99], v[128:143]
    s_add_u32 m0, s39, 2048
    s_mov_b32 s33, 1204224
    buffer_load_dwordx4 v4, s[20:23], s33 offen lds
    v_mfma_f32_32x32x16_bf16 v[144:159], v[64:67], v[100:103], v[144:159]
    s_waitcnt vmcnt(7)
    ds_read_b128 v[104:107], v7 offset:20064
    ds_read_b64_tr_b16 v[80:81], v5 offset:6144
    ds_read_b64_tr_b16 v[82:83], v5 offset:6656
    v_mfma_f32_32x32x16_bf16 v[192:207], v[72:75], v[96:99], v[192:207]
    ds_read_b64_tr_b16 v[84:85], v6 offset:6144
    ds_read_b64_tr_b16 v[86:87], v6 offset:6656
    ds_read_b128 v[108:111], v122 offset:20064
    v_mfma_f32_32x32x16_bf16 v[208:223], v[72:75], v[100:103], v[208:223]
    ds_read_b64_tr_b16 v[88:89], v5 offset:8192
    ds_read_b64_tr_b16 v[90:91], v5 offset:8704
    v_mfma_f32_32x32x16_bf16 v[160:175], v[68:71], v[96:99], v[160:175]
    ds_read_b64_tr_b16 v[92:93], v6 offset:8192
    ds_read_b64_tr_b16 v[94:95], v6 offset:8704
    v_mfma_f32_32x32x16_bf16 v[176:191], v[68:71], v[100:103], v[176:191]
    s_add_u32 m0, s39, 3072
    s_mov_b32 s33, 1232896
    buffer_load_dwordx4 v4, s[20:23], s33 offen lds
    v_mfma_f32_32x32x16_bf16 v[224:239], v[76:79], v[96:99], v[224:239]
    s_add_u32 m0, s39, 4096
    s_mov_b32 s33, 1261568
    buffer_load_dwordx4 v4, s[16:19], s33 offen lds
    v_mfma_f32_32x32x16_bf16 v[240:255], v[76:79], v[100:103], v[240:255]
    s_add_u32 m0, s39, 5120
    s_mov_b32 s33, 1290240
    buffer_load_dwordx4 v4, s[16:19], s33 offen lds
    s_waitcnt lgkmcnt(0)
    v_mfma_f32_32x32x16_bf16 v[128:143], v[80:83], v[104:107], v[128:143]
    s_add_u32 m0, s39, 6144
    s_mov_b32 s33, 1261568
    buffer_load_dwordx4 v4, s[20:23], s33 offen lds
    v_mfma_f32_32x32x16_bf16 v[144:159], v[80:83], v[108:111], v[144:159]
    s_waitcnt vmcnt(7)
    ds_read_b128 v[96:99], v7 offset:21120
    ds_read_b64_tr_b16 v[64:65], v5 offset:10240
    ds_read_b64_tr_b16 v[66:67], v5 offset:10752
    v_mfma_f32_32x32x16_bf16 v[192:207], v[88:91], v[104:107], v[192:207]
    ds_read_b64_tr_b16 v[68:69], v6 offset:10240
    ds_read_b64_tr_b16 v[70:71], v6 offset:10752
    ds_read_b128 v[100:103], v122 offset:21120
    v_mfma_f32_32x32x16_bf16 v[208:223], v[88:91], v[108:111], v[208:223]
    ds_read_b64_tr_b16 v[72:73], v5 offset:12288
    ds_read_b64_tr_b16 v[74:75], v5 offset:12800
    v_mfma_f32_32x32x16_bf16 v[160:175], v[84:87], v[104:107], v[160:175]
    ds_read_b64_tr_b16 v[76:77], v6 offset:12288
    ds_read_b64_tr_b16 v[78:79], v6 offset:12800
    v_mfma_f32_32x32x16_bf16 v[176:191], v[84:87], v[108:111], v[176:191]
    s_add_u32 m0, s39, 7168
    s_mov_b32 s33, 1290240
    buffer_load_dwordx4 v4, s[20:23], s33 offen lds
    v_mfma_f32_32x32x16_bf16 v[224:239], v[92:95], v[104:107], v[224:239]
    s_add_u32 m0, s39, 8192
    s_mov_b32 s33, 1318912
    buffer_load_dwordx4 v4, s[16:19], s33 offen lds
    v_mfma_f32_32x32x16_bf16 v[240:255], v[92:95], v[108:111], v[240:255]
    s_add_u32 m0, s39, 9216
    s_mov_b32 s33, 1347584
    buffer_load_dwordx4 v4, s[16:19], s33 offen lds
    s_waitcnt lgkmcnt(0)
    v_mfma_f32_32x32x16_bf16 v[128:143], v[64:67], v[96:99], v[128:143]
    s_add_u32 m0, s39, 10240
    s_mov_b32 s33, 1318912
    buffer_load_dwordx4 v4, s[20:23], s33 offen lds
    v_mfma_f32_32x32x16_bf16 v[144:159], v[64:67], v[100:103], v[144:159]
    s_waitcnt vmcnt(7)
    ds_read_b128 v[104:107], v7 offset:22176
    ds_read_b64_tr_b16 v[80:81], v5 offset:0
    ds_read_b64_tr_b16 v[82:83], v5 offset:512
    v_mfma_f32_32x32x16_bf16 v[192:207], v[72:75], v[96:99], v[192:207]
    ds_read_b64_tr_b16 v[84:85], v6 offset:0
    ds_read_b64_tr_b16 v[86:87], v6 offset:512
    ds_read_b128 v[108:111], v122 offset:22176
    v_mfma_f32_32x32x16_bf16 v[208:223], v[72:75], v[100:103], v[208:223]
    ds_read_b64_tr_b16 v[88:89], v5 offset:2048
    ds_read_b64_tr_b16 v[90:91], v5 offset:2560
    v_mfma_f32_32x32x16_bf16 v[160:175], v[68:71], v[96:99], v[160:175]
    ds_read_b64_tr_b16 v[92:93], v6 offset:2048
    ds_read_b64_tr_b16 v[94:95], v6 offset:2560
    v_mfma_f32_32x32x16_bf16 v[176:191], v[68:71], v[100:103], v[176:191]
    s_add_u32 m0, s39, 11264
    s_mov_b32 s33, 1347584
    buffer_load_dwordx4 v4, s[20:23], s33 offen lds
    v_mfma_f32_32x32x16_bf16 v[224:239], v[76:79], v[96:99], v[224:239]
    s_add_u32 m0, s39, 12288
    s_mov_b32 s33, 1376256
    buffer_load_dwordx4 v4, s[16:19], s33 offen lds
    v_mfma_f32_32x32x16_bf16 v[240:255], v[76:79], v[100:103], v[240:255]
    s_add_u32 m0, s39, 13312
    s_mov_b32 s33, 1404928
    buffer_load_dwordx4 v4, s[16:19], s33 offen lds
    s_waitcnt lgkmcnt(0)
    v_mfma_f32_32x32x16_bf16 v[128:143], v[80:83], v[104:107], v[128:143]
    s_add_u32 m0, s39, 0
    s_mov_b32 s33, 1376256
    buffer_load_dwordx4 v4, s[20:23], s33 offen lds
    v_mfma_f32_32x32x16_bf16 v[144:159], v[80:83], v[108:111], v[144:159]
    s_waitcnt vmcnt(7)
    ds_read_b128 v[96:99], v7 offset:23232
    ds_read_b64_tr_b16 v[64:65], v5 offset:4096
    ds_read_b64_tr_b16 v[66:67], v5 offset:4608
    v_mfma_f32_32x32x16_bf16 v[192:207], v[88:91], v[104:107], v[192:207]
    ds_read_b64_tr_b16 v[68:69], v6 offset:4096
    ds_read_b64_tr_b16 v[70:71], v6 offset:4608
    ds_read_b128 v[100:103], v122 offset:23232
    v_mfma_f32_32x32x16_bf16 v[208:223], v[88:91], v[108:111], v[208:223]
    ds_read_b64_tr_b16 v[72:73], v5 offset:6144
    ds_read_b64_tr_b16 v[74:75], v5 offset:6656
    v_mfma_f32_32x32x16_bf16 v[160:175], v[84:87], v[104:107], v[160:175]
    ds_read_b64_tr_b16 v[76:77], v6 offset:6144
    ds_read_b64_tr_b16 v[78:79], v6 offset:6656
    v_mfma_f32_32x32x16_bf16 v[176:191], v[84:87], v[108:111], v[176:191]
    s_add_u32 m0, s39, 1024
    s_mov_b32 s33, 1404928
    buffer_load_dwordx4 v4, s[20:23], s33 offen lds
    v_mfma_f32_32x32x16_bf16 v[224:239], v[92:95], v[104:107], v[224:239]
    s_add_u32 m0, s39, 2048
    s_mov_b32 s33, 1433600
    buffer_load_dwordx4 v4, s[16:19], s33 offen lds
    v_mfma_f32_32x32x16_bf16 v[240:255], v[92:95], v[108:111], v[240:255]
    s_add_u32 m0, s39, 3072
    s_mov_b32 s33, 1462272
    buffer_load_dwordx4 v4, s[16:19], s33 offen lds
    s_waitcnt lgkmcnt(0)
    v_mfma_f32_32x32x16_bf16 v[128:143], v[64:67], v[96:99], v[128:143]
    s_add_u32 m0, s39, 4096
    s_mov_b32 s33, 1433600
    buffer_load_dwordx4 v4, s[20:23], s33 offen lds
    v_mfma_f32_32x32x16_bf16 v[144:159], v[64:67], v[100:103], v[144:159]
    s_waitcnt vmcnt(7)
    ds_read_b128 v[104:107], v7 offset:24288
    ds_read_b64_tr_b16 v[80:81], v5 offset:8192
    ds_read_b64_tr_b16 v[82:83], v5 offset:8704
    v_mfma_f32_32x32x16_bf16 v[192:207], v[72:75], v[96:99], v[192:207]
    ds_read_b64_tr_b16 v[84:85], v6 offset:8192
    ds_read_b64_tr_b16 v[86:87], v6 offset:8704
    ds_read_b128 v[108:111], v122 offset:24288
    v_mfma_f32_32x32x16_bf16 v[208:223], v[72:75], v[100:103], v[208:223]
    ds_read_b64_tr_b16 v[88:89], v5 offset:10240
    ds_read_b64_tr_b16 v[90:91], v5 offset:10752
    v_mfma_f32_32x32x16_bf16 v[160:175], v[68:71], v[96:99], v[160:175]
    ds_read_b64_tr_b16 v[92:93], v6 offset:10240
    ds_read_b64_tr_b16 v[94:95], v6 offset:10752
    v_mfma_f32_32x32x16_bf16 v[176:191], v[68:71], v[100:103], v[176:191]
    s_add_u32 m0, s39, 5120
    s_mov_b32 s33, 1462272
    buffer_load_dwordx4 v4, s[20:23], s33 offen lds
    v_mfma_f32_32x32x16_bf16 v[224:239], v[76:79], v[96:99], v[224:239]
    s_add_u32 m0, s39, 6144
    s_mov_b32 s33, 1490944
    buffer_load_dwordx4 v4, s[16:19], s33 offen lds
    v_mfma_f32_32x32x16_bf16 v[240:255], v[76:79], v[100:103], v[240:255]
    s_add_u32 m0, s39, 7168
    s_mov_b32 s33, 1519616
    buffer_load_dwordx4 v4, s[16:19], s33 offen lds
    s_waitcnt lgkmcnt(0)
    v_mfma_f32_32x32x16_bf16 v[128:143], v[80:83], v[104:107], v[128:143]
    s_add_u32 m0, s39, 8192
    s_mov_b32 s33, 1490944
    buffer_load_dwordx4 v4, s[20:23], s33 offen lds
    v_mfma_f32_32x32x16_bf16 v[144:159], v[80:83], v[108:111], v[144:159]
    s_waitcnt vmcnt(7)
    ds_read_b128 v[96:99], v7 offset:25344
    ds_read_b64_tr_b16 v[64:65], v5 offset:12288
    ds_read_b64_tr_b16 v[66:67], v5 offset:12800
    v_mfma_f32_32x32x16_bf16 v[192:207], v[88:91], v[104:107], v[192:207]
    ds_read_b64_tr_b16 v[68:69], v6 offset:12288
    ds_read_b64_tr_b16 v[70:71], v6 offset:12800
    ds_read_b128 v[100:103], v122 offset:25344
    v_mfma_f32_32x32x16_bf16 v[208:223], v[88:91], v[108:111], v[208:223]
    ds_read_b64_tr_b16 v[72:73], v5 offset:0
    ds_read_b64_tr_b16 v[74:75], v5 offset:512
    v_mfma_f32_32x32x16_bf16 v[160:175], v[84:87], v[104:107], v[160:175]
    ds_read_b64_tr_b16 v[76:77], v6 offset:0
    ds_read_b64_tr_b16 v[78:79], v6 offset:512
    v_mfma_f32_32x32x16_bf16 v[176:191], v[84:87], v[108:111], v[176:191]
    s_add_u32 m0, s39, 9216
    s_mov_b32 s33, 1519616
    buffer_load_dwordx4 v4, s[20:23], s33 offen lds
    v_mfma_f32_32x32x16_bf16 v[224:239], v[92:95], v[104:107], v[224:239]
    s_add_u32 m0, s39, 10240
    s_mov_b32 s33, 1548288
    buffer_load_dwordx4 v4, s[16:19], s33 offen lds
    v_mfma_f32_32x32x16_bf16 v[240:255], v[92:95], v[108:111], v[240:255]
    s_add_u32 m0, s39, 11264
    s_mov_b32 s33, 1576960
    buffer_load_dwordx4 v4, s[16:19], s33 offen lds
    s_waitcnt lgkmcnt(0)
    v_mfma_f32_32x32x16_bf16 v[128:143], v[64:67], v[96:99], v[128:143]
    s_add_u32 m0, s39, 12288
    s_mov_b32 s33, 1548288
    buffer_load_dwordx4 v4, s[20:23], s33 offen lds
    v_mfma_f32_32x32x16_bf16 v[144:159], v[64:67], v[100:103], v[144:159]
    s_waitcnt vmcnt(7)
    ds_read_b128 v[104:107], v7 offset:26400
    ds_read_b64_tr_b16 v[80:81], v5 offset:2048
    ds_read_b64_tr_b16 v[82:83], v5 offset:2560
    v_mfma_f32_32x32x16_bf16 v[192:207], v[72:75], v[96:99], v[192:207]
    ds_read_b64_tr_b16 v[84:85], v6 offset:2048
    ds_read_b64_tr_b16 v[86:87], v6 offset:2560
    ds_read_b128 v[108:111], v122 offset:26400
    v_mfma_f32_32x32x16_bf16 v[208:223], v[72:75], v[100:103], v[208:223]
    ds_read_b64_tr_b16 v[88:89], v5 offset:4096
    ds_read_b64_tr_b16 v[90:91], v5 offset:4608
    v_mfma_f32_32x32x16_bf16 v[160:175], v[68:71], v[96:99], v[160:175]
    ds_read_b64_tr_b16 v[92:93], v6 offset:4096
    ds_read_b64_tr_b16 v[94:95], v6 offset:4608
    v_mfma_f32_32x32x16_bf16 v[176:191], v[68:71], v[100:103], v[176:191]
    s_add_u32 m0, s39, 13312
    s_mov_b32 s33, 1576960
    buffer_load_dwordx4 v4, s[20:23], s33 offen lds
    v_mfma_f32_32x32x16_bf16 v[224:239], v[76:79], v[96:99], v[224:239]
    s_add_u32 m0, s39, 0
    s_mov_b32 s33, 1605632
    buffer_load_dwordx4 v4, s[16:19], s33 offen lds
    v_mfma_f32_32x32x16_bf16 v[240:255], v[76:79], v[100:103], v[240:255]
    s_add_u32 m0, s39, 1024
    s_mov_b32 s33, 1634304
    buffer_load_dwordx4 v4, s[16:19], s33 offen lds
    s_waitcnt lgkmcnt(0)
    v_mfma_f32_32x32x16_bf16 v[128:143], v[80:83], v[104:107], v[128:143]
    s_add_u32 m0, s39, 2048
    s_mov_b32 s33, 1605632
    buffer_load_dwordx4 v4, s[20:23], s33 offen lds
    v_mfma_f32_32x32x16_bf16 v[144:159], v[80:83], v[108:111], v[144:159]
    s_waitcnt vmcnt(7)
    ds_read_b128 v[96:99], v7 offset:27456
    ds_read_b64_tr_b16 v[64:65], v5 offset:6144
    ds_read_b64_tr_b16 v[66:67], v5 offset:6656
    v_mfma_f32_32x32x16_bf16 v[192:207], v[88:91], v[104:107], v[192:207]
    ds_read_b64_tr_b16 v[68:69], v6 offset:6144
    ds_read_b64_tr_b16 v[70:71], v6 offset:6656
    ds_read_b128 v[100:103], v122 offset:27456
    v_mfma_f32_32x32x16_bf16 v[208:223], v[88:91], v[108:111], v[208:223]
    ds_read_b64_tr_b16 v[72:73], v5 offset:8192
    ds_read_b64_tr_b16 v[74:75], v5 offset:8704
    v_mfma_f32_32x32x16_bf16 v[160:175], v[84:87], v[104:107], v[160:175]
    ds_read_b64_tr_b16 v[76:77], v6 offset:8192
    ds_read_b64_tr_b16 v[78:79], v6 offset:8704
    v_mfma_f32_32x32x16_bf16 v[176:191], v[84:87], v[108:111], v[176:191]
    s_add_u32 m0, s39, 3072
    s_mov_b32 s33, 1634304
    buffer_load_dwordx4 v4, s[20:23], s33 offen lds
    v_mfma_f32_32x32x16_bf16 v[224:239], v[92:95], v[104:107], v[224:239]
    s_add_u32 m0, s39, 4096
    s_mov_b32 s33, 1662976
    buffer_load_dwordx4 v4, s[16:19], s33 offen lds
    v_mfma_f32_32x32x16_bf16 v[240:255], v[92:95], v[108:111], v[240:255]
    s_add_u32 m0, s39, 5120
    s_mov_b32 s33, 1691648
    buffer_load_dwordx4 v4, s[16:19], s33 offen lds
    s_waitcnt lgkmcnt(0)
    v_mfma_f32_32x32x16_bf16 v[128:143], v[64:67], v[96:99], v[128:143]
    s_add_u32 m0, s39, 6144
    s_mov_b32 s33, 1662976
    buffer_load_dwordx4 v4, s[20:23], s33 offen lds
    v_mfma_f32_32x32x16_bf16 v[144:159], v[64:67], v[100:103], v[144:159]
    s_waitcnt vmcnt(7)
    ds_read_b128 v[104:107], v7 offset:28512
    ds_read_b64_tr_b16 v[80:81], v5 offset:10240
    ds_read_b64_tr_b16 v[82:83], v5 offset:10752
    v_mfma_f32_32x32x16_bf16 v[192:207], v[72:75], v[96:99], v[192:207]
    ds_read_b64_tr_b16 v[84:85], v6 offset:10240
    ds_read_b64_tr_b16 v[86:87], v6 offset:10752
    ds_read_b128 v[108:111], v122 offset:28512
    v_mfma_f32_32x32x16_bf16 v[208:223], v[72:75], v[100:103], v[208:223]
    ds_read_b64_tr_b16 v[88:89], v5 offset:12288
    ds_read_b64_tr_b16 v[90:91], v5 offset:12800
    v_mfma_f32_32x32x16_bf16 v[160:175], v[68:71], v[96:99], v[160:175]
    ds_read_b64_tr_b16 v[92:93], v6 offset:12288
    ds_read_b64_tr_b16 v[94:95], v6 offset:12800
    v_mfma_f32_32x32x16_bf16 v[176:191], v[68:71], v[100:103], v[176:191]
    s_add_u32 m0, s39, 7168
    s_mov_b32 s33, 1691648
    buffer_load_dwordx4 v4, s[20:23], s33 offen lds
    v_mfma_f32_32x32x16_bf16 v[224:239], v[76:79], v[96:99], v[224:239]
    s_add_u32 m0, s39, 8192
    s_mov_b32 s33, 1720320
    buffer_load_dwordx4 v4, s[16:19], s33 offen lds
    v_mfma_f32_32x32x16_bf16 v[240:255], v[76:79], v[100:103], v[240:255]
    s_add_u32 m0, s39, 9216
    s_mov_b32 s33, 1748992
    buffer_load_dwordx4 v4, s[16:19], s33 offen lds
    s_waitcnt lgkmcnt(0)
    v_mfma_f32_32x32x16_bf16 v[128:143], v[80:83], v[104:107], v[128:143]
    s_add_u32 m0, s39, 10240
    s_mov_b32 s33, 1720320
    buffer_load_dwordx4 v4, s[20:23], s33 offen lds
    v_mfma_f32_32x32x16_bf16 v[144:159], v[80:83], v[108:111], v[144:159]
    s_waitcnt vmcnt(7)
    ds_read_b128 v[96:99], v7 offset:29568
    ds_read_b64_tr_b16 v[64:65], v5 offset:0
    ds_read_b64_tr_b16 v[66:67], v5 offset:512
    v_mfma_f32_32x32x16_bf16 v[192:207], v[88:91], v[104:107], v[192:207]
    ds_read_b64_tr_b16 v[68:69], v6 offset:0
    ds_read_b64_tr_b16 v[70:71], v6 offset:512
    ds_read_b128 v[100:103], v122 offset:29568
    v_mfma_f32_32x32x16_bf16 v[208:223], v[88:91], v[108:111], v[208:223]
    ds_read_b64_tr_b16 v[72:73], v5 offset:2048
    ds_read_b64_tr_b16 v[74:75], v5 offset:2560
    v_mfma_f32_32x32x16_bf16 v[160:175], v[84:87], v[104:107], v[160:175]
    ds_read_b64_tr_b16 v[76:77], v6 offset:2048
    ds_read_b64_tr_b16 v[78:79], v6 offset:2560
    v_mfma_f32_32x32x16_bf16 v[176:191], v[84:87], v[108:111], v[176:191]
    s_add_u32 m0, s39, 11264
    s_mov_b32 s33, 1748992
    buffer_load_dwordx4 v4, s[20:23], s33 offen lds
    v_mfma_f32_32x32x16_bf16 v[224:239], v[92:95], v[104:107], v[224:239]
    s_add_u32 m0, s39, 12288
    s_mov_b32 s33, 1777664
    buffer_load_dwordx4 v4, s[16:19], s33 offen lds
    v_mfma_f32_32x32x16_bf16 v[240:255], v[92:95], v[108:111], v[240:255]
    s_add_u32 m0, s39, 13312
    s_mov_b32 s33, 1806336
    buffer_load_dwordx4 v4, s[16:19], s33 offen lds
    s_waitcnt lgkmcnt(0)
    v_mfma_f32_32x32x16_bf16 v[128:143], v[64:67], v[96:99], v[128:143]
    s_add_u32 m0, s39, 0
    s_mov_b32 s33, 1777664
    buffer_load_dwordx4 v4, s[20:23], s33 offen lds
    v_mfma_f32_32x32x16_bf16 v[144:159], v[64:67], v[100:103], v[144:159]
    s_waitcnt vmcnt(7)
    ds_read_b128 v[104:107], v7 offset:30624
    ds_read_b64_tr_b16 v[80:81], v5 offset:4096
    ds_read_b64_tr_b16 v[82:83], v5 offset:4608
    v_mfma_f32_32x32x16_bf16 v[192:207], v[72:75], v[96:99], v[192:207]
    ds_read_b64_tr_b16 v[84:85], v6 offset:4096
    ds_read_b64_tr_b16 v[86:87], v6 offset:4608
    ds_read_b128 v[108:111], v122 offset:30624
    v_mfma_f32_32x32x16_bf16 v[208:223], v[72:75], v[100:103], v[208:223]
    ds_read_b64_tr_b16 v[88:89], v5 offset:6144
    ds_read_b64_tr_b16 v[90:91], v5 offset:6656
    v_mfma_f32_32x32x16_bf16 v[160:175], v[68:71], v[96:99], v[160:175]
    ds_read_b64_tr_b16 v[92:93], v6 offset:6144
    ds_read_b64_tr_b16 v[94:95], v6 offset:6656
    v_mfma_f32_32x32x16_bf16 v[176:191], v[68:71], v[100:103], v[176:191]
    s_add_u32 m0, s39, 1024
    s_mov_b32 s33, 1806336
    buffer_load_dwordx4 v4, s[20:23], s33 offen lds
    v_mfma_f32_32x32x16_bf16 v[224:239], v[76:79], v[96:99], v[224:239]
    v_mfma_f32_32x32x16_bf16 v[240:255], v[76:79], v[100:103], v[240:255]
    s_waitcnt lgkmcnt(0)
    v_mfma_f32_32x32x16_bf16 v[128:143], v[80:83], v[104:107], v[128:143]
    v_mfma_f32_32x32x16_bf16 v[144:159], v[80:83], v[108:111], v[144:159]
    s_waitcnt vmcnt(4)
    ds_read_b128 v[96:99], v7 offset:31680
    ds_read_b64_tr_b16 v[64:65], v5 offset:8192
    ds_read_b64_tr_b16 v[66:67], v5 offset:8704
    v_mfma_f32_32x32x16_bf16 v[192:207], v[88:91], v[104:107], v[192:207]
    ds_read_b64_tr_b16 v[68:69], v6 offset:8192
    ds_read_b64_tr_b16 v[70:71], v6 offset:8704
    ds_read_b128 v[100:103], v122 offset:31680
    v_mfma_f32_32x32x16_bf16 v[208:223], v[88:91], v[108:111], v[208:223]
    ds_read_b64_tr_b16 v[72:73], v5 offset:10240
    ds_read_b64_tr_b16 v[74:75], v5 offset:10752
    v_mfma_f32_32x32x16_bf16 v[160:175], v[84:87], v[104:107], v[160:175]
    ds_read_b64_tr_b16 v[76:77], v6 offset:10240
    ds_read_b64_tr_b16 v[78:79], v6 offset:10752
    v_mfma_f32_32x32x16_bf16 v[176:191], v[84:87], v[108:111], v[176:191]
    v_mfma_f32_32x32x16_bf16 v[224:239], v[92:95], v[104:107], v[224:239]
    v_mfma_f32_32x32x16_bf16 v[240:255], v[92:95], v[108:111], v[240:255]
    s_waitcnt lgkmcnt(0)
    v_mfma_f32_32x32x16_bf16 v[128:143], v[64:67], v[96:99], v[128:143]
    v_mfma_f32_32x32x16_bf16 v[144:159], v[64:67], v[100:103], v[144:159]
    s_waitcnt vmcnt(0)
    ds_read_b128 v[104:107], v7 offset:32736
    ds_read_b64_tr_b16 v[80:81], v5 offset:12288
    ds_read_b64_tr_b16 v[82:83], v5 offset:12800
    v_mfma_f32_32x32x16_bf16 v[192:207], v[72:75], v[96:99], v[192:207]
    ds_read_b64_tr_b16 v[84:85], v6 offset:12288
    ds_read_b64_tr_b16 v[86:87], v6 offset:12800
    ds_read_b128 v[108:111], v122 offset:32736
    v_mfma_f32_32x32x16_bf16 v[208:223], v[72:75], v[100:103], v[208:223]
    ds_read_b64_tr_b16 v[88:89], v5 offset:0
    ds_read_b64_tr_b16 v[90:91], v5 offset:512
    v_mfma_f32_32x32x16_bf16 v[160:175], v[68:71], v[96:99], v[160:175]
    ds_read_b64_tr_b16 v[92:93], v6 offset:0
    ds_read_b64_tr_b16 v[94:95], v6 offset:512
    v_mfma_f32_32x32x16_bf16 v[176:191], v[68:71], v[100:103], v[176:191]
    v_mfma_f32_32x32x16_bf16 v[224:239], v[76:79], v[96:99], v[224:239]
    v_mfma_f32_32x32x16_bf16 v[240:255], v[76:79], v[100:103], v[240:255]
    s_waitcnt lgkmcnt(0)
    v_mfma_f32_32x32x16_bf16 v[128:143], v[80:83], v[104:107], v[128:143]
    v_mfma_f32_32x32x16_bf16 v[144:159], v[80:83], v[108:111], v[144:159]
    v_mfma_f32_32x32x16_bf16 v[192:207], v[88:91], v[104:107], v[192:207]
    v_mfma_f32_32x32x16_bf16 v[208:223], v[88:91], v[108:111], v[208:223]
    v_mfma_f32_32x32x16_bf16 v[160:175], v[84:87], v[104:107], v[160:175]
    v_mfma_f32_32x32x16_bf16 v[176:191], v[84:87], v[108:111], v[176:191]
    v_mfma_f32_32x32x16_bf16 v[224:239], v[92:95], v[104:107], v[224:239]
    v_mfma_f32_32x32x16_bf16 v[240:255], v[92:95], v[108:111], v[240:255]
    s_setprio 0
    v_mov_b32 v9, 106404
    v_mov_b32 v10, 1
    s_mov_b64 exec, 1
    ds_add_u32 v9, v10
    s_mov_b64 exec, -1
    s_setprio 2
    v_lshrrev_b32 v9, 3, v1
    v_bfe_u32 v10, v1, 4, 1
    v_lshlrev_b32 v10, 2, v10
    v_and_b32 v4, 7, v1
    v_xor_b32 v4, v4, v10
    v_lshlrev_b32 v4, 4, v4
    v_mul_u32_u24 v9, 1024, v9
    v_add_u32 v4, v4, v9
    s_lshl_b32 s32, s84, 7
    v_add_u32 v4, s32, v4
    v_bfe_u32 v9, v1, 2, 2
    v_lshrrev_b32 v10, 5, v1
    v_mul_u32_u24 v10, 4, v10
    v_add_u32 v10, v10, v9
    v_lshlrev_b32 v5, 7, v10
    v_lshrrev_b32 v9, 1, v9
    v_xor_b32 v9, s47, v9
    v_lshlrev_b32 v9, 6, v9
    v_add_u32 v5, v5, v9
    v_bfe_u32 v9, v1, 4, 1
    v_lshlrev_b32 v9, 5, v9
    v_add_u32 v5, v5, v9
    v_and_b32 v9, 3, v1
    v_lshlrev_b32 v9, 3, v9
    v_add_u32 v5, v5, v9
    s_xor_b32 s32, s47, 1
    v_bfe_u32 v9, v1, 2, 2
    v_lshrrev_b32 v10, 5, v1
    v_mul_u32_u24 v10, 4, v10
    v_add_u32 v10, v10, v9
    v_lshlrev_b32 v6, 7, v10
    v_lshrrev_b32 v9, 1, v9
    v_xor_b32 v9, s32, v9
    v_lshlrev_b32 v9, 6, v9
    v_add_u32 v6, v6, v9
    v_bfe_u32 v9, v1, 4, 1
    v_lshlrev_b32 v9, 5, v9
    v_add_u32 v6, v6, v9
    v_and_b32 v9, 3, v1
    v_lshlrev_b32 v9, 3, v9
    v_add_u32 v6, v6, v9
    s_lshl_b32 s86, s31, 14
    s_add_u32 s86, s86, 0
    v_add_u32 v13, s86, v5
    v_add_u32 v14, s86, v6
    v_mov_b32 v7, v5
    v_add_u32 v5, s39, v5
    v_add_u32 v6, s39, v6
    v_min_u32 v11, 6, v1
    v_lshlrev_b32 v11, 2, v11
    s_lshl_b32 s32, s83, 1
    s_add_u32 s32, s32, s96
    s_lshl_b32 s32, s32, 15
    s_lshl_b32 s33, s84, 7
    s_add_u32 s32, s32, s33
    s_lshl_b32 s33, s47, 6
    s_add_u32 s32, s32, s33
    v_and_b32 v12, 31, v1
    v_lshlrev_b32 v12, 10, v12
    v_lshrrev_b32 v9, 5, v1
    v_lshlrev_b32 v9, 3, v9
    v_add_u32 v12, v12, v9
    v_add_u32 v12, s32, v12
    s_setprio 0
    s_mov_b32 s24, s64
    s_mov_b32 s25, s65
    s_mov_b32 s26, 0x1c0000
    s_mov_b32 s27, 0x00020000
    s_mov_b32 s16, s56
    s_mov_b32 s17, s57
    s_mov_b32 s18, 0x80000
    s_mov_b32 s19, 0x00020000
    s_mul_i32 s97, s31, 458752
    s_lshl_b32 s32, s83, 1
    s_add_u32 s32, s32, s96
    s_mul_i32 s98, s32, 114688
    s_xor_b32 s32, s32, 1
    s_mul_i32 s99, s32, 114688
    s_mul_i32 s32, s31, 28672
    s_add_u32 s32, s32, 5242880
    s_add_u32 s98, s98, s32
    s_add_u32 s99, s99, s32
    v_mov_b32 v9, 106368
    s_mov_b32 s37, 65536
L_ldsw_70:
    ds_read_b32 v10, v9
    s_waitcnt lgkmcnt(0)
    v_readfirstlane_b32 s38, v10
    s_nop 3
    s_cmp_ge_u32 s38, 1
    s_cbranch_scc1 L_ldsd_71
    s_sub_u32 s37, s37, 1
    s_cmp_eq_u32 s37, 0
    s_cbranch_scc1 recurrent_scan__grouped_kv_mqa__swiglu_ffn__prompt_kernel_end
    s_branch L_ldsw_70
L_ldsd_71:
    s_lshl_b32 s34, s28, 1
    s_mul_i32 s34, s34, 112
    s_lshl_b32 s33, s29, 4
    s_add_u32 s34, s34, s33
    s_lshl_b32 s33, s31, 2
    s_add_u32 s34, s34, s33
    s_lshl_b32 s34, s34, 10
    s_add_u32 s34, s34, 5242880
    s_setprio 2
    v_pk_mul_f32 v[64:65], v[128:129], s[44:45] op_sel_hi:[1,0]
    v_pk_mul_f32 v[66:67], v[130:131], s[44:45] op_sel_hi:[1,0]
    v_pk_mul_f32 v[68:69], v[132:133], s[44:45] op_sel_hi:[1,0]
    v_pk_mul_f32 v[70:71], v[134:135], s[44:45] op_sel_hi:[1,0]
    v_pk_mul_f32 v[72:73], v[136:137], s[44:45] op_sel_hi:[1,0]
    v_pk_mul_f32 v[74:75], v[138:139], s[44:45] op_sel_hi:[1,0]
    v_pk_mul_f32 v[76:77], v[140:141], s[44:45] op_sel_hi:[1,0]
    v_pk_mul_f32 v[78:79], v[142:143], s[44:45] op_sel_hi:[1,0]
    v_exp_f32 v64, v64
    v_exp_f32 v65, v65
    v_exp_f32 v66, v66
    v_exp_f32 v67, v67
    v_exp_f32 v68, v68
    v_exp_f32 v69, v69
    v_exp_f32 v70, v70
    v_exp_f32 v71, v71
    v_exp_f32 v72, v72
    v_exp_f32 v73, v73
    v_exp_f32 v74, v74
    v_exp_f32 v75, v75
    v_exp_f32 v76, v76
    v_exp_f32 v77, v77
    v_exp_f32 v78, v78
    v_exp_f32 v79, v79
    s_nop 0
    v_pk_add_f32 v[64:65], v[64:65], 1.0 op_sel_hi:[1,0]
    v_pk_add_f32 v[66:67], v[66:67], 1.0 op_sel_hi:[1,0]
    v_pk_add_f32 v[68:69], v[68:69], 1.0 op_sel_hi:[1,0]
    v_pk_add_f32 v[70:71], v[70:71], 1.0 op_sel_hi:[1,0]
    v_pk_add_f32 v[72:73], v[72:73], 1.0 op_sel_hi:[1,0]
    v_pk_add_f32 v[74:75], v[74:75], 1.0 op_sel_hi:[1,0]
    v_pk_add_f32 v[76:77], v[76:77], 1.0 op_sel_hi:[1,0]
    v_pk_add_f32 v[78:79], v[78:79], 1.0 op_sel_hi:[1,0]
    v_rcp_f32 v64, v64
    v_rcp_f32 v65, v65
    v_rcp_f32 v66, v66
    v_rcp_f32 v67, v67
    v_rcp_f32 v68, v68
    v_rcp_f32 v69, v69
    v_rcp_f32 v70, v70
    v_rcp_f32 v71, v71
    v_rcp_f32 v72, v72
    v_rcp_f32 v73, v73
    v_rcp_f32 v74, v74
    v_rcp_f32 v75, v75
    v_rcp_f32 v76, v76
    v_rcp_f32 v77, v77
    v_rcp_f32 v78, v78
    v_rcp_f32 v79, v79
    s_nop 0
    v_pk_mul_f32 v[128:129], v[128:129], v[192:193]
    v_pk_mul_f32 v[130:131], v[130:131], v[194:195]
    v_pk_mul_f32 v[132:133], v[132:133], v[196:197]
    v_pk_mul_f32 v[134:135], v[134:135], v[198:199]
    v_pk_mul_f32 v[136:137], v[136:137], v[200:201]
    v_pk_mul_f32 v[138:139], v[138:139], v[202:203]
    v_pk_mul_f32 v[140:141], v[140:141], v[204:205]
    v_pk_mul_f32 v[142:143], v[142:143], v[206:207]
    v_pk_mul_f32 v[128:129], v[128:129], v[64:65]
    v_pk_mul_f32 v[130:131], v[130:131], v[66:67]
    v_pk_mul_f32 v[132:133], v[132:133], v[68:69]
    v_pk_mul_f32 v[134:135], v[134:135], v[70:71]
    v_pk_mul_f32 v[136:137], v[136:137], v[72:73]
    v_pk_mul_f32 v[138:139], v[138:139], v[74:75]
    v_pk_mul_f32 v[140:141], v[140:141], v[76:77]
    v_pk_mul_f32 v[142:143], v[142:143], v[78:79]
    v_cvt_pk_bf16_f32 v80, v128, v129
    v_cvt_pk_bf16_f32 v81, v130, v131
    v_cvt_pk_bf16_f32 v82, v132, v133
    v_cvt_pk_bf16_f32 v83, v134, v135
    v_cvt_pk_bf16_f32 v84, v136, v137
    v_cvt_pk_bf16_f32 v85, v138, v139
    v_cvt_pk_bf16_f32 v86, v140, v141
    v_cvt_pk_bf16_f32 v87, v142, v143
    s_setprio 0
    s_add_u32 s32, s34, 0
    buffer_store_dwordx4 v[80:83], v2, s[8:11], s32 offen sc1
    buffer_store_dwordx4 v[84:87], v2, s[8:11], s32 offen offset:1024 sc1
    s_setprio 2
    v_pk_mul_f32 v[64:65], v[144:145], s[44:45] op_sel_hi:[1,0]
    v_pk_mul_f32 v[66:67], v[146:147], s[44:45] op_sel_hi:[1,0]
    v_pk_mul_f32 v[68:69], v[148:149], s[44:45] op_sel_hi:[1,0]
    v_pk_mul_f32 v[70:71], v[150:151], s[44:45] op_sel_hi:[1,0]
    v_pk_mul_f32 v[72:73], v[152:153], s[44:45] op_sel_hi:[1,0]
    v_pk_mul_f32 v[74:75], v[154:155], s[44:45] op_sel_hi:[1,0]
    v_pk_mul_f32 v[76:77], v[156:157], s[44:45] op_sel_hi:[1,0]
    v_pk_mul_f32 v[78:79], v[158:159], s[44:45] op_sel_hi:[1,0]
    v_exp_f32 v64, v64
    v_exp_f32 v65, v65
    v_exp_f32 v66, v66
    v_exp_f32 v67, v67
    v_exp_f32 v68, v68
    v_exp_f32 v69, v69
    v_exp_f32 v70, v70
    v_exp_f32 v71, v71
    v_exp_f32 v72, v72
    v_exp_f32 v73, v73
    v_exp_f32 v74, v74
    v_exp_f32 v75, v75
    v_exp_f32 v76, v76
    v_exp_f32 v77, v77
    v_exp_f32 v78, v78
    v_exp_f32 v79, v79
    s_nop 0
    v_pk_add_f32 v[64:65], v[64:65], 1.0 op_sel_hi:[1,0]
    v_pk_add_f32 v[66:67], v[66:67], 1.0 op_sel_hi:[1,0]
    v_pk_add_f32 v[68:69], v[68:69], 1.0 op_sel_hi:[1,0]
    v_pk_add_f32 v[70:71], v[70:71], 1.0 op_sel_hi:[1,0]
    v_pk_add_f32 v[72:73], v[72:73], 1.0 op_sel_hi:[1,0]
    v_pk_add_f32 v[74:75], v[74:75], 1.0 op_sel_hi:[1,0]
    v_pk_add_f32 v[76:77], v[76:77], 1.0 op_sel_hi:[1,0]
    v_pk_add_f32 v[78:79], v[78:79], 1.0 op_sel_hi:[1,0]
    v_rcp_f32 v64, v64
    v_rcp_f32 v65, v65
    v_rcp_f32 v66, v66
    v_rcp_f32 v67, v67
    v_rcp_f32 v68, v68
    v_rcp_f32 v69, v69
    v_rcp_f32 v70, v70
    v_rcp_f32 v71, v71
    v_rcp_f32 v72, v72
    v_rcp_f32 v73, v73
    v_rcp_f32 v74, v74
    v_rcp_f32 v75, v75
    v_rcp_f32 v76, v76
    v_rcp_f32 v77, v77
    v_rcp_f32 v78, v78
    v_rcp_f32 v79, v79
    s_nop 0
    v_pk_mul_f32 v[144:145], v[144:145], v[208:209]
    v_pk_mul_f32 v[146:147], v[146:147], v[210:211]
    v_pk_mul_f32 v[148:149], v[148:149], v[212:213]
    v_pk_mul_f32 v[150:151], v[150:151], v[214:215]
    v_pk_mul_f32 v[152:153], v[152:153], v[216:217]
    v_pk_mul_f32 v[154:155], v[154:155], v[218:219]
    v_pk_mul_f32 v[156:157], v[156:157], v[220:221]
    v_pk_mul_f32 v[158:159], v[158:159], v[222:223]
    v_pk_mul_f32 v[144:145], v[144:145], v[64:65]
    v_pk_mul_f32 v[146:147], v[146:147], v[66:67]
    v_pk_mul_f32 v[148:149], v[148:149], v[68:69]
    v_pk_mul_f32 v[150:151], v[150:151], v[70:71]
    v_pk_mul_f32 v[152:153], v[152:153], v[72:73]
    v_pk_mul_f32 v[154:155], v[154:155], v[74:75]
    v_pk_mul_f32 v[156:157], v[156:157], v[76:77]
    v_pk_mul_f32 v[158:159], v[158:159], v[78:79]
    v_cvt_pk_bf16_f32 v88, v144, v145
    v_cvt_pk_bf16_f32 v89, v146, v147
    v_cvt_pk_bf16_f32 v90, v148, v149
    v_cvt_pk_bf16_f32 v91, v150, v151
    v_cvt_pk_bf16_f32 v92, v152, v153
    v_cvt_pk_bf16_f32 v93, v154, v155
    v_cvt_pk_bf16_f32 v94, v156, v157
    v_cvt_pk_bf16_f32 v95, v158, v159
    s_setprio 0
    s_add_u32 s32, s34, 114688
    buffer_store_dwordx4 v[88:91], v2, s[8:11], s32 offen sc1
    buffer_store_dwordx4 v[92:95], v2, s[8:11], s32 offen offset:1024 sc1
    s_setprio 2
    v_pk_mul_f32 v[64:65], v[160:161], s[44:45] op_sel_hi:[1,0]
    v_pk_mul_f32 v[66:67], v[162:163], s[44:45] op_sel_hi:[1,0]
    v_pk_mul_f32 v[68:69], v[164:165], s[44:45] op_sel_hi:[1,0]
    v_pk_mul_f32 v[70:71], v[166:167], s[44:45] op_sel_hi:[1,0]
    v_pk_mul_f32 v[72:73], v[168:169], s[44:45] op_sel_hi:[1,0]
    v_pk_mul_f32 v[74:75], v[170:171], s[44:45] op_sel_hi:[1,0]
    v_pk_mul_f32 v[76:77], v[172:173], s[44:45] op_sel_hi:[1,0]
    v_pk_mul_f32 v[78:79], v[174:175], s[44:45] op_sel_hi:[1,0]
    v_exp_f32 v64, v64
    v_exp_f32 v65, v65
    v_exp_f32 v66, v66
    v_exp_f32 v67, v67
    v_exp_f32 v68, v68
    v_exp_f32 v69, v69
    v_exp_f32 v70, v70
    v_exp_f32 v71, v71
    v_exp_f32 v72, v72
    v_exp_f32 v73, v73
    v_exp_f32 v74, v74
    v_exp_f32 v75, v75
    v_exp_f32 v76, v76
    v_exp_f32 v77, v77
    v_exp_f32 v78, v78
    v_exp_f32 v79, v79
    s_nop 0
    v_pk_add_f32 v[64:65], v[64:65], 1.0 op_sel_hi:[1,0]
    v_pk_add_f32 v[66:67], v[66:67], 1.0 op_sel_hi:[1,0]
    v_pk_add_f32 v[68:69], v[68:69], 1.0 op_sel_hi:[1,0]
    v_pk_add_f32 v[70:71], v[70:71], 1.0 op_sel_hi:[1,0]
    v_pk_add_f32 v[72:73], v[72:73], 1.0 op_sel_hi:[1,0]
    v_pk_add_f32 v[74:75], v[74:75], 1.0 op_sel_hi:[1,0]
    v_pk_add_f32 v[76:77], v[76:77], 1.0 op_sel_hi:[1,0]
    v_pk_add_f32 v[78:79], v[78:79], 1.0 op_sel_hi:[1,0]
    v_rcp_f32 v64, v64
    v_rcp_f32 v65, v65
    v_rcp_f32 v66, v66
    v_rcp_f32 v67, v67
    v_rcp_f32 v68, v68
    v_rcp_f32 v69, v69
    v_rcp_f32 v70, v70
    v_rcp_f32 v71, v71
    v_rcp_f32 v72, v72
    v_rcp_f32 v73, v73
    v_rcp_f32 v74, v74
    v_rcp_f32 v75, v75
    v_rcp_f32 v76, v76
    v_rcp_f32 v77, v77
    v_rcp_f32 v78, v78
    v_rcp_f32 v79, v79
    s_nop 0
    v_pk_mul_f32 v[160:161], v[160:161], v[224:225]
    v_pk_mul_f32 v[162:163], v[162:163], v[226:227]
    v_pk_mul_f32 v[164:165], v[164:165], v[228:229]
    v_pk_mul_f32 v[166:167], v[166:167], v[230:231]
    v_pk_mul_f32 v[168:169], v[168:169], v[232:233]
    v_pk_mul_f32 v[170:171], v[170:171], v[234:235]
    v_pk_mul_f32 v[172:173], v[172:173], v[236:237]
    v_pk_mul_f32 v[174:175], v[174:175], v[238:239]
    v_pk_mul_f32 v[160:161], v[160:161], v[64:65]
    v_pk_mul_f32 v[162:163], v[162:163], v[66:67]
    v_pk_mul_f32 v[164:165], v[164:165], v[68:69]
    v_pk_mul_f32 v[166:167], v[166:167], v[70:71]
    v_pk_mul_f32 v[168:169], v[168:169], v[72:73]
    v_pk_mul_f32 v[170:171], v[170:171], v[74:75]
    v_pk_mul_f32 v[172:173], v[172:173], v[76:77]
    v_pk_mul_f32 v[174:175], v[174:175], v[78:79]
    v_cvt_pk_bf16_f32 v80, v160, v161
    v_cvt_pk_bf16_f32 v81, v162, v163
    v_cvt_pk_bf16_f32 v82, v164, v165
    v_cvt_pk_bf16_f32 v83, v166, v167
    v_cvt_pk_bf16_f32 v84, v168, v169
    v_cvt_pk_bf16_f32 v85, v170, v171
    v_cvt_pk_bf16_f32 v86, v172, v173
    v_cvt_pk_bf16_f32 v87, v174, v175
    s_setprio 0
    s_add_u32 s32, s34, 2048
    buffer_store_dwordx4 v[80:83], v2, s[8:11], s32 offen sc1
    buffer_store_dwordx4 v[84:87], v2, s[8:11], s32 offen offset:1024 sc1
    s_setprio 2
    v_pk_mul_f32 v[64:65], v[176:177], s[44:45] op_sel_hi:[1,0]
    v_pk_mul_f32 v[66:67], v[178:179], s[44:45] op_sel_hi:[1,0]
    v_pk_mul_f32 v[68:69], v[180:181], s[44:45] op_sel_hi:[1,0]
    v_pk_mul_f32 v[70:71], v[182:183], s[44:45] op_sel_hi:[1,0]
    v_pk_mul_f32 v[72:73], v[184:185], s[44:45] op_sel_hi:[1,0]
    v_pk_mul_f32 v[74:75], v[186:187], s[44:45] op_sel_hi:[1,0]
    v_pk_mul_f32 v[76:77], v[188:189], s[44:45] op_sel_hi:[1,0]
    v_pk_mul_f32 v[78:79], v[190:191], s[44:45] op_sel_hi:[1,0]
    v_exp_f32 v64, v64
    v_exp_f32 v65, v65
    v_exp_f32 v66, v66
    v_exp_f32 v67, v67
    v_exp_f32 v68, v68
    v_exp_f32 v69, v69
    v_exp_f32 v70, v70
    v_exp_f32 v71, v71
    v_exp_f32 v72, v72
    v_exp_f32 v73, v73
    v_exp_f32 v74, v74
    v_exp_f32 v75, v75
    v_exp_f32 v76, v76
    v_exp_f32 v77, v77
    v_exp_f32 v78, v78
    v_exp_f32 v79, v79
    s_nop 0
    v_pk_add_f32 v[64:65], v[64:65], 1.0 op_sel_hi:[1,0]
    v_pk_add_f32 v[66:67], v[66:67], 1.0 op_sel_hi:[1,0]
    v_pk_add_f32 v[68:69], v[68:69], 1.0 op_sel_hi:[1,0]
    v_pk_add_f32 v[70:71], v[70:71], 1.0 op_sel_hi:[1,0]
    v_pk_add_f32 v[72:73], v[72:73], 1.0 op_sel_hi:[1,0]
    v_pk_add_f32 v[74:75], v[74:75], 1.0 op_sel_hi:[1,0]
    v_pk_add_f32 v[76:77], v[76:77], 1.0 op_sel_hi:[1,0]
    v_pk_add_f32 v[78:79], v[78:79], 1.0 op_sel_hi:[1,0]
    v_rcp_f32 v64, v64
    v_rcp_f32 v65, v65
    v_rcp_f32 v66, v66
    v_rcp_f32 v67, v67
    v_rcp_f32 v68, v68
    v_rcp_f32 v69, v69
    v_rcp_f32 v70, v70
    v_rcp_f32 v71, v71
    v_rcp_f32 v72, v72
    v_rcp_f32 v73, v73
    v_rcp_f32 v74, v74
    v_rcp_f32 v75, v75
    v_rcp_f32 v76, v76
    v_rcp_f32 v77, v77
    v_rcp_f32 v78, v78
    v_rcp_f32 v79, v79
    s_nop 0
    v_pk_mul_f32 v[176:177], v[176:177], v[240:241]
    v_pk_mul_f32 v[178:179], v[178:179], v[242:243]
    v_pk_mul_f32 v[180:181], v[180:181], v[244:245]
    v_pk_mul_f32 v[182:183], v[182:183], v[246:247]
    v_pk_mul_f32 v[184:185], v[184:185], v[248:249]
    v_pk_mul_f32 v[186:187], v[186:187], v[250:251]
    v_pk_mul_f32 v[188:189], v[188:189], v[252:253]
    v_pk_mul_f32 v[190:191], v[190:191], v[254:255]
    v_pk_mul_f32 v[176:177], v[176:177], v[64:65]
    v_pk_mul_f32 v[178:179], v[178:179], v[66:67]
    v_pk_mul_f32 v[180:181], v[180:181], v[68:69]
    v_pk_mul_f32 v[182:183], v[182:183], v[70:71]
    v_pk_mul_f32 v[184:185], v[184:185], v[72:73]
    v_pk_mul_f32 v[186:187], v[186:187], v[74:75]
    v_pk_mul_f32 v[188:189], v[188:189], v[76:77]
    v_pk_mul_f32 v[190:191], v[190:191], v[78:79]
    v_cvt_pk_bf16_f32 v88, v176, v177
    v_cvt_pk_bf16_f32 v89, v178, v179
    v_cvt_pk_bf16_f32 v90, v180, v181
    v_cvt_pk_bf16_f32 v91, v182, v183
    v_cvt_pk_bf16_f32 v92, v184, v185
    v_cvt_pk_bf16_f32 v93, v186, v187
    v_cvt_pk_bf16_f32 v94, v188, v189
    v_cvt_pk_bf16_f32 v95, v190, v191
    s_setprio 0
    s_add_u32 s32, s34, 116736
    buffer_store_dwordx4 v[88:91], v2, s[8:11], s32 offen sc1
    buffer_store_dwordx4 v[92:95], v2, s[8:11], s32 offen offset:1024 sc1
    s_waitcnt vmcnt(0)
    s_lshl_b32 s32, s28, 9
    s_lshl_b32 s33, s29, 4
    s_add_u32 s32, s32, s33
    s_lshl_b32 s33, s31, 2
    s_add_u32 s32, s32, s33
    s_add_u32 s32, s32, 4391040
    v_mov_b32 v9, 0
    v_mov_b32 v10, s38
    s_mov_b64 exec, 1
    buffer_store_dword v10, v9, s[8:11], s32 offen sc1
    s_mov_b64 exec, -1
    s_setprio 0
    s_add_u32 m0, s39, 0
    s_add_u32 s32, s97, 0
    buffer_load_dwordx4 v4, s[24:27], s32 offen lds
    s_add_u32 m0, s39, 1024
    s_add_u32 s32, s97, 8192
    buffer_load_dwordx4 v4, s[24:27], s32 offen lds
    s_add_u32 m0, s39, 2048
    s_add_u32 s32, s97, 16384
    buffer_load_dwordx4 v4, s[24:27], s32 offen lds
    s_add_u32 m0, s39, 3072
    s_add_u32 s32, s97, 24576
    buffer_load_dwordx4 v4, s[24:27], s32 offen lds
    s_add_u32 m0, s39, 4096
    s_add_u32 s32, s97, 32768
    buffer_load_dwordx4 v4, s[24:27], s32 offen lds
    s_add_u32 m0, s39, 5120
    s_add_u32 s32, s97, 40960
    buffer_load_dwordx4 v4, s[24:27], s32 offen lds
    s_add_u32 m0, s39, 6144
    s_add_u32 s32, s97, 49152
    buffer_load_dwordx4 v4, s[24:27], s32 offen lds
    s_add_u32 m0, s39, 7168
    s_add_u32 s32, s97, 57344
    buffer_load_dwordx4 v4, s[24:27], s32 offen lds
    s_add_u32 m0, s39, 8192
    s_add_u32 s32, s97, 65536
    buffer_load_dwordx4 v4, s[24:27], s32 offen lds
    s_add_u32 m0, s39, 9216
    s_add_u32 s32, s97, 73728
    buffer_load_dwordx4 v4, s[24:27], s32 offen lds
    s_add_u32 m0, s39, 10240
    s_add_u32 s32, s97, 81920
    buffer_load_dwordx4 v4, s[24:27], s32 offen lds
    s_add_u32 m0, s39, 11264
    s_add_u32 s32, s97, 90112
    buffer_load_dwordx4 v4, s[24:27], s32 offen lds
    s_add_u32 m0, s39, 12288
    s_add_u32 s32, s97, 98304
    buffer_load_dwordx4 v4, s[24:27], s32 offen lds
    s_add_u32 m0, s39, 13312
    s_add_u32 s32, s97, 106496
    buffer_load_dwordx4 v4, s[24:27], s32 offen lds
    s_branch L_gemm2_69
L_kvunit_68:
    s_setprio 2
    v_mov_b32 v9, 0
    buffer_load_dword v12, v9, s[40:43], 0 offen sc1
L_dry_kv:
    ds_read_b128 v[96:99], v5 offset:0
    ds_read_b64_tr_b16 v[64:65], v6 offset:0
    ds_read_b64_tr_b16 v[66:67], v6 offset:256
    ds_read_b64_tr_b16 v[80:81], v6 offset:2048
    ds_read_b64_tr_b16 v[82:83], v6 offset:2304
    ds_read_b128 v[100:103], v5 offset:2112
    ds_read_b64_tr_b16 v[68:69], v6 offset:1024
    ds_read_b64_tr_b16 v[70:71], v6 offset:1280
    ds_read_b64_tr_b16 v[84:85], v6 offset:3072
    ds_read_b64_tr_b16 v[86:87], v6 offset:3328
    ds_read_b128 v[104:107], v5 offset:4224
    ds_read_b64_tr_b16 v[72:73], v6 offset:4096
    ds_read_b64_tr_b16 v[74:75], v6 offset:4352
    ds_read_b64_tr_b16 v[88:89], v6 offset:6144
    ds_read_b64_tr_b16 v[90:91], v6 offset:6400
    s_waitcnt lgkmcnt(10)
    v_mfma_f32_16x16x32_bf16 v[40:43], v[64:67], v[96:99], 0
    v_mfma_f32_16x16x32_bf16 v[44:47], v[96:99], v[80:83], 0
    ds_read_b128 v[96:99], v5 offset:6336
    ds_read_b64_tr_b16 v[64:65], v6 offset:5120
    ds_read_b64_tr_b16 v[66:67], v6 offset:5376
    ds_read_b64_tr_b16 v[80:81], v6 offset:7168
    ds_read_b64_tr_b16 v[82:83], v6 offset:7424
    s_waitcnt lgkmcnt(10)
    v_mfma_f32_16x16x32_bf16 v[40:43], v[68:71], v[100:103], v[40:43]
    v_mfma_f32_16x16x32_bf16 v[44:47], v[100:103], v[84:87], v[44:47]
    ds_read_b128 v[100:103], v5 offset:8448
    ds_read_b64_tr_b16 v[68:69], v6 offset:8192
    ds_read_b64_tr_b16 v[70:71], v6 offset:8448
    ds_read_b64_tr_b16 v[84:85], v6 offset:10240
    ds_read_b64_tr_b16 v[86:87], v6 offset:10496
    s_waitcnt lgkmcnt(10)
    v_mfma_f32_16x16x32_bf16 v[40:43], v[72:75], v[104:107], v[40:43]
    v_mfma_f32_16x16x32_bf16 v[44:47], v[104:107], v[88:91], v[44:47]
    ds_read_b128 v[104:107], v5 offset:10560
    ds_read_b64_tr_b16 v[72:73], v6 offset:9216
    ds_read_b64_tr_b16 v[74:75], v6 offset:9472
    ds_read_b64_tr_b16 v[88:89], v6 offset:11264
    ds_read_b64_tr_b16 v[90:91], v6 offset:11520
    s_waitcnt lgkmcnt(10)
    v_mfma_f32_16x16x32_bf16 v[40:43], v[64:67], v[96:99], v[40:43]
    v_mfma_f32_16x16x32_bf16 v[44:47], v[96:99], v[80:83], v[44:47]
    ds_read_b128 v[96:99], v5 offset:12672
    ds_read_b64_tr_b16 v[64:65], v6 offset:12288
    ds_read_b64_tr_b16 v[66:67], v6 offset:12544
    ds_read_b64_tr_b16 v[80:81], v6 offset:14336
    ds_read_b64_tr_b16 v[82:83], v6 offset:14592
    s_waitcnt lgkmcnt(10)
    v_mfma_f32_16x16x32_bf16 v[40:43], v[68:71], v[100:103], v[40:43]
    v_mfma_f32_16x16x32_bf16 v[44:47], v[100:103], v[84:87], v[44:47]
    ds_read_b128 v[100:103], v5 offset:14784
    ds_read_b64_tr_b16 v[68:69], v6 offset:13312
    ds_read_b64_tr_b16 v[70:71], v6 offset:13568
    ds_read_b64_tr_b16 v[84:85], v6 offset:15360
    ds_read_b64_tr_b16 v[86:87], v6 offset:15616
    s_waitcnt lgkmcnt(10)
    v_mfma_f32_16x16x32_bf16 v[40:43], v[72:75], v[104:107], v[40:43]
    v_mfma_f32_16x16x32_bf16 v[44:47], v[104:107], v[88:91], v[44:47]
    ds_read_b128 v[104:107], v5 offset:16896
    ds_read_b64_tr_b16 v[72:73], v6 offset:16384
    ds_read_b64_tr_b16 v[74:75], v6 offset:16640
    ds_read_b64_tr_b16 v[88:89], v6 offset:18432
    ds_read_b64_tr_b16 v[90:91], v6 offset:18688
    s_waitcnt lgkmcnt(10)
    v_mfma_f32_16x16x32_bf16 v[40:43], v[64:67], v[96:99], v[40:43]
    v_mfma_f32_16x16x32_bf16 v[44:47], v[96:99], v[80:83], v[44:47]
    ds_read_b128 v[96:99], v5 offset:19008
    ds_read_b64_tr_b16 v[64:65], v6 offset:17408
    ds_read_b64_tr_b16 v[66:67], v6 offset:17664
    ds_read_b64_tr_b16 v[80:81], v6 offset:19456
    ds_read_b64_tr_b16 v[82:83], v6 offset:19712
    s_waitcnt lgkmcnt(10)
    v_mfma_f32_16x16x32_bf16 v[40:43], v[68:71], v[100:103], v[40:43]
    v_mfma_f32_16x16x32_bf16 v[44:47], v[100:103], v[84:87], v[44:47]
    ds_read_b128 v[100:103], v5 offset:21120
    ds_read_b64_tr_b16 v[68:69], v6 offset:20480
    ds_read_b64_tr_b16 v[70:71], v6 offset:20736
    ds_read_b64_tr_b16 v[84:85], v6 offset:22528
    ds_read_b64_tr_b16 v[86:87], v6 offset:22784
    s_waitcnt lgkmcnt(10)
    v_mfma_f32_16x16x32_bf16 v[40:43], v[72:75], v[104:107], v[40:43]
    v_mfma_f32_16x16x32_bf16 v[44:47], v[104:107], v[88:91], v[44:47]
    ds_read_b128 v[104:107], v5 offset:23232
    ds_read_b64_tr_b16 v[72:73], v6 offset:21504
    ds_read_b64_tr_b16 v[74:75], v6 offset:21760
    ds_read_b64_tr_b16 v[88:89], v6 offset:23552
    ds_read_b64_tr_b16 v[90:91], v6 offset:23808
    s_waitcnt lgkmcnt(10)
    v_mfma_f32_16x16x32_bf16 v[40:43], v[64:67], v[96:99], v[40:43]
    v_mfma_f32_16x16x32_bf16 v[44:47], v[96:99], v[80:83], v[44:47]
    ds_read_b128 v[96:99], v5 offset:25344
    ds_read_b64_tr_b16 v[64:65], v6 offset:24576
    ds_read_b64_tr_b16 v[66:67], v6 offset:24832
    ds_read_b64_tr_b16 v[80:81], v6 offset:26624
    ds_read_b64_tr_b16 v[82:83], v6 offset:26880
    s_waitcnt lgkmcnt(10)
    v_mfma_f32_16x16x32_bf16 v[40:43], v[68:71], v[100:103], v[40:43]
    v_mfma_f32_16x16x32_bf16 v[44:47], v[100:103], v[84:87], v[44:47]
    ds_read_b128 v[100:103], v5 offset:27456
    ds_read_b64_tr_b16 v[68:69], v6 offset:25600
    ds_read_b64_tr_b16 v[70:71], v6 offset:25856
    ds_read_b64_tr_b16 v[84:85], v6 offset:27648
    ds_read_b64_tr_b16 v[86:87], v6 offset:27904
    s_waitcnt lgkmcnt(10)
    v_mfma_f32_16x16x32_bf16 v[40:43], v[72:75], v[104:107], v[40:43]
    v_mfma_f32_16x16x32_bf16 v[44:47], v[104:107], v[88:91], v[44:47]
    ds_read_b128 v[104:107], v5 offset:29568
    ds_read_b64_tr_b16 v[72:73], v6 offset:28672
    ds_read_b64_tr_b16 v[74:75], v6 offset:28928
    ds_read_b64_tr_b16 v[88:89], v6 offset:30720
    ds_read_b64_tr_b16 v[90:91], v6 offset:30976
    s_waitcnt lgkmcnt(10)
    v_mfma_f32_16x16x32_bf16 v[40:43], v[64:67], v[96:99], v[40:43]
    v_mfma_f32_16x16x32_bf16 v[44:47], v[96:99], v[80:83], v[44:47]
    ds_read_b128 v[96:99], v5 offset:31680
    ds_read_b64_tr_b16 v[64:65], v6 offset:29696
    ds_read_b64_tr_b16 v[66:67], v6 offset:29952
    ds_read_b64_tr_b16 v[80:81], v6 offset:31744
    ds_read_b64_tr_b16 v[82:83], v6 offset:32000
    s_waitcnt lgkmcnt(10)
    v_mfma_f32_16x16x32_bf16 v[40:43], v[68:71], v[100:103], v[40:43]
    v_mfma_f32_16x16x32_bf16 v[44:47], v[100:103], v[84:87], v[44:47]
    s_waitcnt lgkmcnt(5)
    v_mfma_f32_16x16x32_bf16 v[40:43], v[72:75], v[104:107], v[40:43]
    v_mfma_f32_16x16x32_bf16 v[44:47], v[104:107], v[88:91], v[44:47]
    s_waitcnt lgkmcnt(0)
    v_mfma_f32_16x16x32_bf16 v[40:43], v[64:67], v[96:99], v[40:43]
    v_mfma_f32_16x16x32_bf16 v[44:47], v[96:99], v[80:83], v[44:47]
    s_cmp_eq_u32 s85, 1
    s_cbranch_scc1 L_dry_ret
    v_mov_b32 v10, 0x3f803f80
    v_cmp_eq_u32 vcc, 0, v1
    v_lshlrev_b32 v9, 4, v1
    v_add_u32 v9, 512, v9
    v_cndmask_b32 v52, 0, v10, vcc
    v_mov_b32 v53, v52
    v_mov_b32 v54, v52
    v_mov_b32 v55, v52
    s_nop 1
    v_cvt_pk_bf16_f32 v48, v40, v41
    v_cvt_pk_bf16_f32 v49, v42, v43
    v_cvt_pk_bf16_f32 v50, v44, v45
    v_cvt_pk_bf16_f32 v51, v46, v47
    buffer_store_dwordx2 v[48:49], v7, s[8:11], s81 offen sc1
    buffer_store_dwordx2 v[50:51], v122, s[8:11], s82 offen sc1
    s_mov_b64 exec, 3
    buffer_store_dwordx4 v[52:55], v9, s[8:11], s82 offen sc1
    s_mov_b64 exec, -1
    v_mov_b32 v9, 106404
    v_mov_b32 v10, 1
    s_mov_b64 exec, 1
    ds_add_u32 v9, v10
    s_mov_b64 exec, -1
    v_mul_f32 v57, v40, v40
    v_fma_f32 v57, v41, v41, v57
    v_fma_f32 v57, v42, v42, v57
    v_fma_f32 v57, v43, v43, v57
    v_max_f32 v58, |v44|, |v45|
    v_max3_f32 v58, |v46|, |v47|, v58
    v_mov_b32 v9, v57
    s_nop 1
    v_permlane16_swap_b32 v9, v57
    s_nop 1
    v_add_f32 v57, v57, v9
    v_mov_b32 v9, v57
    s_nop 1
    v_permlane32_swap_b32 v9, v57
    s_nop 1
    v_add_f32 v57, v57, v9
    s_nop 1
    v_max_f32_dpp v57, v57, v57 row_ror:8 row_mask:0xf bank_mask:0xf
    s_nop 0
    v_max_f32_dpp v58, v58, v58 row_ror:8 row_mask:0xf bank_mask:0xf
    s_nop 0
    v_max_f32_dpp v57, v57, v57 row_ror:4 row_mask:0xf bank_mask:0xf
    s_nop 0
    v_max_f32_dpp v58, v58, v58 row_ror:4 row_mask:0xf bank_mask:0xf
    s_nop 0
    v_max_f32_dpp v57, v57, v57 row_ror:2 row_mask:0xf bank_mask:0xf
    s_nop 0
    v_max_f32_dpp v58, v58, v58 row_ror:2 row_mask:0xf bank_mask:0xf
    s_nop 0
    v_max_f32_dpp v57, v57, v57 row_ror:1 row_mask:0xf bank_mask:0xf
    s_nop 0
    v_max_f32_dpp v58, v58, v58 row_ror:1 row_mask:0xf bank_mask:0xf
    s_nop 0
    v_mov_b32 v9, v58
    s_nop 1
    v_permlane16_swap_b32 v9, v58
    s_nop 1
    v_max_f32 v58, v58, v9
    v_mov_b32 v9, v58
    s_nop 1
    v_permlane32_swap_b32 v9, v58
    s_nop 1
    v_max_f32 v58, v58, v9
    s_lshl_b32 s36, s28, 9
    s_lshl_b32 s33, s31, 4
    s_add_u32 s36, s36, s33
    s_add_u32 s36, s36, 4390912
    v_mov_b32 v59, 0
    s_waitcnt vmcnt(0)
    v_readfirstlane_b32 s38, v12
    s_nop 3
    s_cmp_lg_u32 s38, 0
    s_cbranch_scc1 L_hn_72
    s_mov_b32 s37, 65536
L_nf_73:
    v_mov_b32 v9, 0
    buffer_load_dword v10, v9, s[40:43], 0 offen sc1
    s_waitcnt vmcnt(0)
    v_readfirstlane_b32 s38, v10
    s_nop 3
    s_cmp_lg_u32 s38, 0
    s_cbranch_scc1 L_nfd_74
    s_sub_u32 s37, s37, 1
    s_cmp_eq_u32 s37, 0
    s_cbranch_scc1 recurrent_scan__grouped_kv_mqa__swiglu_ffn__prompt_kernel_end
    s_sleep 2
    s_branch L_nf_73
L_nfd_74:
L_hn_72:
    v_mov_b32 v56, s38
    v_mov_b32 v9, 0
    s_mov_b64 exec, 1
    buffer_store_dwordx4 v[56:59], v9, s[8:11], s36 offen sc1
    s_mov_b64 exec, -1
    s_setprio 0
    s_setprio 2
    v_lshrrev_b32 v9, 3, v1
    v_bfe_u32 v10, v1, 4, 1
    v_lshlrev_b32 v10, 2, v10
    v_and_b32 v4, 7, v1
    v_xor_b32 v4, v4, v10
    v_lshlrev_b32 v4, 4, v4
    v_mul_u32_u24 v9, 1024, v9
    v_add_u32 v4, v4, v9
    s_lshl_b32 s32, s84, 7
    v_add_u32 v4, s32, v4
    v_bfe_u32 v9, v1, 2, 2
    v_lshrrev_b32 v10, 5, v1
    v_mul_u32_u24 v10, 4, v10
    v_add_u32 v10, v10, v9
    v_lshlrev_b32 v5, 7, v10
    v_lshrrev_b32 v9, 1, v9
    v_xor_b32 v9, s47, v9
    v_lshlrev_b32 v9, 6, v9
    v_add_u32 v5, v5, v9
    v_bfe_u32 v9, v1, 4, 1
    v_lshlrev_b32 v9, 5, v9
    v_add_u32 v5, v5, v9
    v_and_b32 v9, 3, v1
    v_lshlrev_b32 v9, 3, v9
    v_add_u32 v5, v5, v9
    s_xor_b32 s32, s47, 1
    v_bfe_u32 v9, v1, 2, 2
    v_lshrrev_b32 v10, 5, v1
    v_mul_u32_u24 v10, 4, v10
    v_add_u32 v10, v10, v9
    v_lshlrev_b32 v6, 7, v10
    v_lshrrev_b32 v9, 1, v9
    v_xor_b32 v9, s32, v9
    v_lshlrev_b32 v9, 6, v9
    v_add_u32 v6, v6, v9
    v_bfe_u32 v9, v1, 4, 1
    v_lshlrev_b32 v9, 5, v9
    v_add_u32 v6, v6, v9
    v_and_b32 v9, 3, v1
    v_lshlrev_b32 v9, 3, v9
    v_add_u32 v6, v6, v9
    s_lshl_b32 s86, s31, 14
    s_add_u32 s86, s86, 0
    v_add_u32 v13, s86, v5
    v_add_u32 v14, s86, v6
    v_mov_b32 v7, v5
    v_add_u32 v5, s39, v5
    v_add_u32 v6, s39, v6
    v_min_u32 v11, 6, v1
    v_lshlrev_b32 v11, 2, v11
    s_lshl_b32 s32, s83, 1
    s_add_u32 s32, s32, s96
    s_lshl_b32 s32, s32, 15
    s_lshl_b32 s33, s84, 7
    s_add_u32 s32, s32, s33
    s_lshl_b32 s33, s47, 6
    s_add_u32 s32, s32, s33
    v_and_b32 v12, 31, v1
    v_lshlrev_b32 v12, 10, v12
    v_lshrrev_b32 v9, 5, v1
    v_lshlrev_b32 v9, 3, v9
    v_add_u32 v12, v12, v9
    v_add_u32 v12, s32, v12
    s_setprio 0
    s_mov_b32 s24, s64
    s_mov_b32 s25, s65
    s_mov_b32 s26, 0x1c0000
    s_mov_b32 s27, 0x00020000
    s_mov_b32 s16, s56
    s_mov_b32 s17, s57
    s_mov_b32 s18, 0x80000
    s_mov_b32 s19, 0x00020000
    s_mul_i32 s97, s31, 458752
    s_lshl_b32 s32, s83, 1
    s_add_u32 s32, s32, s96
    s_mul_i32 s98, s32, 114688
    s_xor_b32 s32, s32, 1
    s_mul_i32 s99, s32, 114688
    s_mul_i32 s32, s31, 28672
    s_add_u32 s32, s32, 5242880
    s_add_u32 s98, s98, s32
    s_add_u32 s99, s99, s32
    v_mov_b32 v9, 106404
    s_mov_b32 s37, 65536
L_ldsw_75:
    ds_read_b32 v10, v9
    s_waitcnt lgkmcnt(0)
    v_readfirstlane_b32 s32, v10
    s_nop 3
    s_cmp_ge_u32 s32, 4
    s_cbranch_scc1 L_ldsd_76
    s_sub_u32 s37, s37, 1
    s_cmp_eq_u32 s37, 0
    s_cbranch_scc1 recurrent_scan__grouped_kv_mqa__swiglu_ffn__prompt_kernel_end
    s_sleep 1
    s_branch L_ldsw_75
L_ldsd_76:
    s_add_u32 m0, s39, 0
    s_add_u32 s32, s97, 0
    buffer_load_dwordx4 v4, s[24:27], s32 offen lds
    s_add_u32 m0, s39, 1024
    s_add_u32 s32, s97, 8192
    buffer_load_dwordx4 v4, s[24:27], s32 offen lds
    s_add_u32 m0, s39, 2048
    s_add_u32 s32, s97, 16384
    buffer_load_dwordx4 v4, s[24:27], s32 offen lds
    s_add_u32 m0, s39, 3072
    s_add_u32 s32, s97, 24576
    buffer_load_dwordx4 v4, s[24:27], s32 offen lds
    s_add_u32 m0, s39, 4096
    s_add_u32 s32, s97, 32768
    buffer_load_dwordx4 v4, s[24:27], s32 offen lds
    s_add_u32 m0, s39, 5120
    s_add_u32 s32, s97, 40960
    buffer_load_dwordx4 v4, s[24:27], s32 offen lds
    s_add_u32 m0, s39, 6144
    s_add_u32 s32, s97, 49152
    buffer_load_dwordx4 v4, s[24:27], s32 offen lds
    s_add_u32 m0, s39, 7168
    s_add_u32 s32, s97, 57344
    buffer_load_dwordx4 v4, s[24:27], s32 offen lds
    s_add_u32 m0, s39, 8192
    s_add_u32 s32, s97, 65536
    buffer_load_dwordx4 v4, s[24:27], s32 offen lds
    s_add_u32 m0, s39, 9216
    s_add_u32 s32, s97, 73728
    buffer_load_dwordx4 v4, s[24:27], s32 offen lds
    s_add_u32 m0, s39, 10240
    s_add_u32 s32, s97, 81920
    buffer_load_dwordx4 v4, s[24:27], s32 offen lds
    s_add_u32 m0, s39, 11264
    s_add_u32 s32, s97, 90112
    buffer_load_dwordx4 v4, s[24:27], s32 offen lds
    s_add_u32 m0, s39, 12288
    s_add_u32 s32, s97, 98304
    buffer_load_dwordx4 v4, s[24:27], s32 offen lds
    s_add_u32 m0, s39, 13312
    s_add_u32 s32, s97, 106496
    buffer_load_dwordx4 v4, s[24:27], s32 offen lds
L_gemm2_69:
    v_mov_b32 v9, 106368
    s_mov_b32 s37, 65536
L_ldsw_77:
    ds_read_b32 v10, v9
    s_waitcnt lgkmcnt(0)
    v_readfirstlane_b32 s38, v10
    s_nop 3
    s_cmp_ge_u32 s38, 1
    s_cbranch_scc1 L_ldsd_78
    s_sub_u32 s37, s37, 1
    s_cmp_eq_u32 s37, 0
    s_cbranch_scc1 recurrent_scan__grouped_kv_mqa__swiglu_ffn__prompt_kernel_end
    s_sleep 1
    s_branch L_ldsw_77
L_ldsd_78:
    s_lshl_b32 s34, s83, 9
    s_mul_i32 s33, s31, 28
    s_add_u32 s34, s34, s33
    s_add_u32 s34, s34, 4391040
    s_mov_b32 s37, 65536
L_poll_79:
    buffer_load_dword v10, v11, s[8:11], s34 offen sc1
    s_waitcnt vmcnt(0)
    v_cmp_eq_u32 vcc, s38, v10
    s_nop 4
    s_cmp_eq_u64 vcc, exec
    s_cbranch_scc1 L_polld_80
    s_sub_u32 s37, s37, 1
    s_cmp_eq_u32 s37, 0
    s_cbranch_scc1 recurrent_scan__grouped_kv_mqa__swiglu_ffn__prompt_kernel_end
    s_sleep 2
    s_branch L_poll_79
L_polld_80:
    s_add_u32 s32, s98, 0
    buffer_load_dwordx4 v[64:67], v2, s[8:11], s32 offen offset:0 sc1
    s_add_u32 s32, s99, 0
    buffer_load_dwordx4 v[68:71], v2, s[8:11], s32 offen offset:0 sc1
    s_add_u32 s32, s98, 0
    buffer_load_dwordx4 v[72:75], v2, s[8:11], s32 offen offset:1024 sc1
    s_add_u32 s32, s99, 0
    buffer_load_dwordx4 v[76:79], v2, s[8:11], s32 offen offset:1024 sc1
    s_add_u32 s32, s98, 0
    buffer_load_dwordx4 v[80:83], v2, s[8:11], s32 offen offset:2048 sc1
    s_add_u32 s32, s99, 0
    buffer_load_dwordx4 v[84:87], v2, s[8:11], s32 offen offset:2048 sc1
    s_add_u32 s32, s98, 0
    buffer_load_dwordx4 v[88:91], v2, s[8:11], s32 offen offset:3072 sc1
    s_add_u32 s32, s99, 0
    buffer_load_dwordx4 v[92:95], v2, s[8:11], s32 offen offset:3072 sc1
    s_add_u32 s32, s98, 4096
    buffer_load_dwordx4 v[96:99], v2, s[8:11], s32 offen offset:0 sc1
    s_add_u32 s32, s99, 4096
    buffer_load_dwordx4 v[100:103], v2, s[8:11], s32 offen offset:0 sc1
    s_add_u32 s32, s98, 4096
    buffer_load_dwordx4 v[104:107], v2, s[8:11], s32 offen offset:1024 sc1
    s_add_u32 s32, s99, 4096
    buffer_load_dwordx4 v[108:111], v2, s[8:11], s32 offen offset:1024 sc1
    ds_read_b64_tr_b16 v[192:193], v5 offset:0
    ds_read_b64_tr_b16 v[194:195], v5 offset:1024
    ds_read_b64_tr_b16 v[196:197], v6 offset:0
    ds_read_b64_tr_b16 v[198:199], v6 offset:1024
    s_waitcnt vmcnt(10) lgkmcnt(0)
    ds_read_b64_tr_b16 v[200:201], v5 offset:2048
    ds_read_b64_tr_b16 v[202:203], v5 offset:3072
    ds_read_b64_tr_b16 v[204:205], v6 offset:2048
    ds_read_b64_tr_b16 v[206:207], v6 offset:3072
    s_add_u32 s32, s98, 4096
    buffer_load_dwordx4 v[112:115], v2, s[8:11], s32 offen offset:2048 sc1
    s_add_u32 s32, s99, 4096
    buffer_load_dwordx4 v[116:119], v2, s[8:11], s32 offen offset:2048 sc1
    s_add_u32 m0, s39, 0
    s_add_u32 s32, s97, 114688
    buffer_load_dwordx4 v4, s[24:27], s32 offen lds
    s_add_u32 m0, s39, 1024
    s_add_u32 s32, s97, 122880
    buffer_load_dwordx4 v4, s[24:27], s32 offen lds
    v_mfma_f32_32x32x16_bf16 v[128:143], v[192:195], v[64:67], 0
    v_mfma_f32_32x32x16_bf16 v[144:159], v[192:195], v[68:71], 0
    v_mfma_f32_32x32x16_bf16 v[160:175], v[196:199], v[64:67], 0
    v_mfma_f32_32x32x16_bf16 v[176:191], v[196:199], v[68:71], 0
    s_waitcnt vmcnt(12) lgkmcnt(0)
    ds_read_b64_tr_b16 v[208:209], v5 offset:4096
    ds_read_b64_tr_b16 v[210:211], v5 offset:5120
    ds_read_b64_tr_b16 v[212:213], v6 offset:4096
    ds_read_b64_tr_b16 v[214:215], v6 offset:5120
    s_add_u32 s32, s98, 4096
    buffer_load_dwordx4 v[64:67], v2, s[8:11], s32 offen offset:3072 sc1
    s_add_u32 s32, s99, 4096
    buffer_load_dwordx4 v[68:71], v2, s[8:11], s32 offen offset:3072 sc1
    s_add_u32 m0, s39, 2048
    s_add_u32 s32, s97, 131072
    buffer_load_dwordx4 v4, s[24:27], s32 offen lds
    s_add_u32 m0, s39, 3072
    s_add_u32 s32, s97, 139264
    buffer_load_dwordx4 v4, s[24:27], s32 offen lds
    v_mfma_f32_32x32x16_bf16 v[128:143], v[200:203], v[72:75], v[128:143]
    v_mfma_f32_32x32x16_bf16 v[144:159], v[200:203], v[76:79], v[144:159]
    v_mfma_f32_32x32x16_bf16 v[160:175], v[204:207], v[72:75], v[160:175]
    v_mfma_f32_32x32x16_bf16 v[176:191], v[204:207], v[76:79], v[176:191]
    s_waitcnt vmcnt(14) lgkmcnt(0)
    ds_read_b64_tr_b16 v[216:217], v5 offset:6144
    ds_read_b64_tr_b16 v[218:219], v5 offset:7168
    ds_read_b64_tr_b16 v[220:221], v6 offset:6144
    ds_read_b64_tr_b16 v[222:223], v6 offset:7168
    s_add_u32 s32, s98, 8192
    buffer_load_dwordx4 v[72:75], v2, s[8:11], s32 offen offset:0 sc1
    s_add_u32 s32, s99, 8192
    buffer_load_dwordx4 v[76:79], v2, s[8:11], s32 offen offset:0 sc1
    s_add_u32 m0, s39, 4096
    s_add_u32 s32, s97, 147456
    buffer_load_dwordx4 v4, s[24:27], s32 offen lds
    s_add_u32 m0, s39, 5120
    s_add_u32 s32, s97, 155648
    buffer_load_dwordx4 v4, s[24:27], s32 offen lds
    v_mfma_f32_32x32x16_bf16 v[128:143], v[208:211], v[80:83], v[128:143]
    v_mfma_f32_32x32x16_bf16 v[144:159], v[208:211], v[84:87], v[144:159]
    v_mfma_f32_32x32x16_bf16 v[160:175], v[212:215], v[80:83], v[160:175]
    v_mfma_f32_32x32x16_bf16 v[176:191], v[212:215], v[84:87], v[176:191]
    s_waitcnt vmcnt(16) lgkmcnt(0)
    ds_read_b64_tr_b16 v[224:225], v5 offset:8192
    ds_read_b64_tr_b16 v[226:227], v5 offset:9216
    ds_read_b64_tr_b16 v[228:229], v6 offset:8192
    ds_read_b64_tr_b16 v[230:231], v6 offset:9216
    s_add_u32 s32, s98, 8192
    buffer_load_dwordx4 v[80:83], v2, s[8:11], s32 offen offset:1024 sc1
    s_add_u32 s32, s99, 8192
    buffer_load_dwordx4 v[84:87], v2, s[8:11], s32 offen offset:1024 sc1
    s_add_u32 m0, s39, 6144
    s_add_u32 s32, s97, 163840
    buffer_load_dwordx4 v4, s[24:27], s32 offen lds
    s_add_u32 m0, s39, 7168
    s_add_u32 s32, s97, 172032
    buffer_load_dwordx4 v4, s[24:27], s32 offen lds
    v_mfma_f32_32x32x16_bf16 v[128:143], v[216:219], v[88:91], v[128:143]
    v_mfma_f32_32x32x16_bf16 v[144:159], v[216:219], v[92:95], v[144:159]
    v_mfma_f32_32x32x16_bf16 v[160:175], v[220:223], v[88:91], v[160:175]
    v_mfma_f32_32x32x16_bf16 v[176:191], v[220:223], v[92:95], v[176:191]
    s_waitcnt vmcnt(18) lgkmcnt(0)
    ds_read_b64_tr_b16 v[232:233], v5 offset:10240
    ds_read_b64_tr_b16 v[234:235], v5 offset:11264
    ds_read_b64_tr_b16 v[236:237], v6 offset:10240
    ds_read_b64_tr_b16 v[238:239], v6 offset:11264
    s_add_u32 s32, s98, 8192
    buffer_load_dwordx4 v[88:91], v2, s[8:11], s32 offen offset:2048 sc1
    s_add_u32 s32, s99, 8192
    buffer_load_dwordx4 v[92:95], v2, s[8:11], s32 offen offset:2048 sc1
    s_add_u32 m0, s39, 8192
    s_add_u32 s32, s97, 180224
    buffer_load_dwordx4 v4, s[24:27], s32 offen lds
    s_add_u32 m0, s39, 9216
    s_add_u32 s32, s97, 188416
    buffer_load_dwordx4 v4, s[24:27], s32 offen lds
    v_mfma_f32_32x32x16_bf16 v[128:143], v[224:227], v[96:99], v[128:143]
    v_mfma_f32_32x32x16_bf16 v[144:159], v[224:227], v[100:103], v[144:159]
    v_mfma_f32_32x32x16_bf16 v[160:175], v[228:231], v[96:99], v[160:175]
    v_mfma_f32_32x32x16_bf16 v[176:191], v[228:231], v[100:103], v[176:191]
    s_waitcnt vmcnt(20) lgkmcnt(0)
    ds_read_b64_tr_b16 v[240:241], v5 offset:12288
    ds_read_b64_tr_b16 v[242:243], v5 offset:13312
    ds_read_b64_tr_b16 v[244:245], v6 offset:12288
    ds_read_b64_tr_b16 v[246:247], v6 offset:13312
    s_add_u32 s32, s98, 8192
    buffer_load_dwordx4 v[96:99], v2, s[8:11], s32 offen offset:3072 sc1
    s_add_u32 s32, s99, 8192
    buffer_load_dwordx4 v[100:103], v2, s[8:11], s32 offen offset:3072 sc1
    s_add_u32 m0, s39, 10240
    s_add_u32 s32, s97, 196608
    buffer_load_dwordx4 v4, s[24:27], s32 offen lds
    s_add_u32 m0, s39, 11264
    s_add_u32 s32, s97, 204800
    buffer_load_dwordx4 v4, s[24:27], s32 offen lds
    v_mfma_f32_32x32x16_bf16 v[128:143], v[232:235], v[104:107], v[128:143]
    v_mfma_f32_32x32x16_bf16 v[144:159], v[232:235], v[108:111], v[144:159]
    v_mfma_f32_32x32x16_bf16 v[160:175], v[236:239], v[104:107], v[160:175]
    v_mfma_f32_32x32x16_bf16 v[176:191], v[236:239], v[108:111], v[176:191]
    s_waitcnt vmcnt(20) lgkmcnt(0)
    ds_read_b64_tr_b16 v[192:193], v5 offset:0
    ds_read_b64_tr_b16 v[194:195], v5 offset:1024
    ds_read_b64_tr_b16 v[196:197], v6 offset:0
    ds_read_b64_tr_b16 v[198:199], v6 offset:1024
    s_add_u32 s32, s98, 12288
    buffer_load_dwordx4 v[104:107], v2, s[8:11], s32 offen offset:0 sc1
    s_add_u32 s32, s99, 12288
    buffer_load_dwordx4 v[108:111], v2, s[8:11], s32 offen offset:0 sc1
    s_add_u32 m0, s39, 12288
    s_add_u32 s32, s97, 212992
    buffer_load_dwordx4 v4, s[24:27], s32 offen lds
    s_add_u32 m0, s39, 13312
    s_add_u32 s32, s97, 221184
    buffer_load_dwordx4 v4, s[24:27], s32 offen lds
    v_mfma_f32_32x32x16_bf16 v[128:143], v[240:243], v[112:115], v[128:143]
    v_mfma_f32_32x32x16_bf16 v[144:159], v[240:243], v[116:119], v[144:159]
    v_mfma_f32_32x32x16_bf16 v[160:175], v[244:247], v[112:115], v[160:175]
    v_mfma_f32_32x32x16_bf16 v[176:191], v[244:247], v[116:119], v[176:191]
    s_waitcnt vmcnt(20) lgkmcnt(0)
    ds_read_b64_tr_b16 v[200:201], v5 offset:2048
    ds_read_b64_tr_b16 v[202:203], v5 offset:3072
    ds_read_b64_tr_b16 v[204:205], v6 offset:2048
    ds_read_b64_tr_b16 v[206:207], v6 offset:3072
    s_add_u32 s32, s98, 12288
    buffer_load_dwordx4 v[112:115], v2, s[8:11], s32 offen offset:1024 sc1
    s_add_u32 s32, s99, 12288
    buffer_load_dwordx4 v[116:119], v2, s[8:11], s32 offen offset:1024 sc1
    s_add_u32 m0, s39, 0
    s_add_u32 s32, s97, 229376
    buffer_load_dwordx4 v4, s[24:27], s32 offen lds
    s_add_u32 m0, s39, 1024
    s_add_u32 s32, s97, 237568
    buffer_load_dwordx4 v4, s[24:27], s32 offen lds
    v_mfma_f32_32x32x16_bf16 v[128:143], v[192:195], v[64:67], v[128:143]
    v_mfma_f32_32x32x16_bf16 v[144:159], v[192:195], v[68:71], v[144:159]
    v_mfma_f32_32x32x16_bf16 v[160:175], v[196:199], v[64:67], v[160:175]
    v_mfma_f32_32x32x16_bf16 v[176:191], v[196:199], v[68:71], v[176:191]
    s_waitcnt vmcnt(20) lgkmcnt(0)
    ds_read_b64_tr_b16 v[208:209], v5 offset:4096
    ds_read_b64_tr_b16 v[210:211], v5 offset:5120
    ds_read_b64_tr_b16 v[212:213], v6 offset:4096
    ds_read_b64_tr_b16 v[214:215], v6 offset:5120
    s_add_u32 s32, s98, 12288
    buffer_load_dwordx4 v[64:67], v2, s[8:11], s32 offen offset:2048 sc1
    s_add_u32 s32, s99, 12288
    buffer_load_dwordx4 v[68:71], v2, s[8:11], s32 offen offset:2048 sc1
    s_add_u32 m0, s39, 2048
    s_add_u32 s32, s97, 245760
    buffer_load_dwordx4 v4, s[24:27], s32 offen lds
    s_add_u32 m0, s39, 3072
    s_add_u32 s32, s97, 253952
    buffer_load_dwordx4 v4, s[24:27], s32 offen lds
    v_mfma_f32_32x32x16_bf16 v[128:143], v[200:203], v[72:75], v[128:143]
    v_mfma_f32_32x32x16_bf16 v[144:159], v[200:203], v[76:79], v[144:159]
    v_mfma_f32_32x32x16_bf16 v[160:175], v[204:207], v[72:75], v[160:175]
    v_mfma_f32_32x32x16_bf16 v[176:191], v[204:207], v[76:79], v[176:191]
    s_waitcnt vmcnt(20) lgkmcnt(0)
    ds_read_b64_tr_b16 v[216:217], v5 offset:6144
    ds_read_b64_tr_b16 v[218:219], v5 offset:7168
    ds_read_b64_tr_b16 v[220:221], v6 offset:6144
    ds_read_b64_tr_b16 v[222:223], v6 offset:7168
    s_add_u32 s32, s98, 12288
    buffer_load_dwordx4 v[72:75], v2, s[8:11], s32 offen offset:3072 sc1
    s_add_u32 s32, s99, 12288
    buffer_load_dwordx4 v[76:79], v2, s[8:11], s32 offen offset:3072 sc1
    s_add_u32 m0, s39, 4096
    s_add_u32 s32, s97, 262144
    buffer_load_dwordx4 v4, s[24:27], s32 offen lds
    s_add_u32 m0, s39, 5120
    s_add_u32 s32, s97, 270336
    buffer_load_dwordx4 v4, s[24:27], s32 offen lds
    v_mfma_f32_32x32x16_bf16 v[128:143], v[208:211], v[80:83], v[128:143]
    v_mfma_f32_32x32x16_bf16 v[144:159], v[208:211], v[84:87], v[144:159]
    v_mfma_f32_32x32x16_bf16 v[160:175], v[212:215], v[80:83], v[160:175]
    v_mfma_f32_32x32x16_bf16 v[176:191], v[212:215], v[84:87], v[176:191]
    s_waitcnt vmcnt(20) lgkmcnt(0)
    ds_read_b64_tr_b16 v[224:225], v5 offset:8192
    ds_read_b64_tr_b16 v[226:227], v5 offset:9216
    ds_read_b64_tr_b16 v[228:229], v6 offset:8192
    ds_read_b64_tr_b16 v[230:231], v6 offset:9216
    s_add_u32 s32, s98, 16384
    buffer_load_dwordx4 v[80:83], v2, s[8:11], s32 offen offset:0 sc1
    s_add_u32 s32, s99, 16384
    buffer_load_dwordx4 v[84:87], v2, s[8:11], s32 offen offset:0 sc1
    s_add_u32 m0, s39, 6144
    s_add_u32 s32, s97, 278528
    buffer_load_dwordx4 v4, s[24:27], s32 offen lds
    s_add_u32 m0, s39, 7168
    s_add_u32 s32, s97, 286720
    buffer_load_dwordx4 v4, s[24:27], s32 offen lds
    v_mfma_f32_32x32x16_bf16 v[128:143], v[216:219], v[88:91], v[128:143]
    v_mfma_f32_32x32x16_bf16 v[144:159], v[216:219], v[92:95], v[144:159]
    v_mfma_f32_32x32x16_bf16 v[160:175], v[220:223], v[88:91], v[160:175]
    v_mfma_f32_32x32x16_bf16 v[176:191], v[220:223], v[92:95], v[176:191]
    s_waitcnt vmcnt(20) lgkmcnt(0)
    ds_read_b64_tr_b16 v[232:233], v5 offset:10240
    ds_read_b64_tr_b16 v[234:235], v5 offset:11264
    ds_read_b64_tr_b16 v[236:237], v6 offset:10240
    ds_read_b64_tr_b16 v[238:239], v6 offset:11264
    s_add_u32 s32, s98, 16384
    buffer_load_dwordx4 v[88:91], v2, s[8:11], s32 offen offset:1024 sc1
    s_add_u32 s32, s99, 16384
    buffer_load_dwordx4 v[92:95], v2, s[8:11], s32 offen offset:1024 sc1
    s_add_u32 m0, s39, 8192
    s_add_u32 s32, s97, 294912
    buffer_load_dwordx4 v4, s[24:27], s32 offen lds
    s_add_u32 m0, s39, 9216
    s_add_u32 s32, s97, 303104
    buffer_load_dwordx4 v4, s[24:27], s32 offen lds
    v_mfma_f32_32x32x16_bf16 v[128:143], v[224:227], v[96:99], v[128:143]
    v_mfma_f32_32x32x16_bf16 v[144:159], v[224:227], v[100:103], v[144:159]
    v_mfma_f32_32x32x16_bf16 v[160:175], v[228:231], v[96:99], v[160:175]
    v_mfma_f32_32x32x16_bf16 v[176:191], v[228:231], v[100:103], v[176:191]
    s_waitcnt vmcnt(20) lgkmcnt(0)
    ds_read_b64_tr_b16 v[240:241], v5 offset:12288
    ds_read_b64_tr_b16 v[242:243], v5 offset:13312
    ds_read_b64_tr_b16 v[244:245], v6 offset:12288
    ds_read_b64_tr_b16 v[246:247], v6 offset:13312
    s_add_u32 s32, s98, 16384
    buffer_load_dwordx4 v[96:99], v2, s[8:11], s32 offen offset:2048 sc1
    s_add_u32 s32, s99, 16384
    buffer_load_dwordx4 v[100:103], v2, s[8:11], s32 offen offset:2048 sc1
    s_add_u32 m0, s39, 10240
    s_add_u32 s32, s97, 311296
    buffer_load_dwordx4 v4, s[24:27], s32 offen lds
    s_add_u32 m0, s39, 11264
    s_add_u32 s32, s97, 319488
    buffer_load_dwordx4 v4, s[24:27], s32 offen lds
    v_mfma_f32_32x32x16_bf16 v[128:143], v[232:235], v[104:107], v[128:143]
    v_mfma_f32_32x32x16_bf16 v[144:159], v[232:235], v[108:111], v[144:159]
    v_mfma_f32_32x32x16_bf16 v[160:175], v[236:239], v[104:107], v[160:175]
    v_mfma_f32_32x32x16_bf16 v[176:191], v[236:239], v[108:111], v[176:191]
    s_waitcnt vmcnt(20) lgkmcnt(0)
    ds_read_b64_tr_b16 v[192:193], v5 offset:0
    ds_read_b64_tr_b16 v[194:195], v5 offset:1024
    ds_read_b64_tr_b16 v[196:197], v6 offset:0
    ds_read_b64_tr_b16 v[198:199], v6 offset:1024
    s_add_u32 s32, s98, 16384
    buffer_load_dwordx4 v[104:107], v2, s[8:11], s32 offen offset:3072 sc1
    s_add_u32 s32, s99, 16384
    buffer_load_dwordx4 v[108:111], v2, s[8:11], s32 offen offset:3072 sc1
    s_add_u32 m0, s39, 12288
    s_add_u32 s32, s97, 327680
    buffer_load_dwordx4 v4, s[24:27], s32 offen lds
    s_add_u32 m0, s39, 13312
    s_add_u32 s32, s97, 335872
    buffer_load_dwordx4 v4, s[24:27], s32 offen lds
    v_mfma_f32_32x32x16_bf16 v[128:143], v[240:243], v[112:115], v[128:143]
    v_mfma_f32_32x32x16_bf16 v[144:159], v[240:243], v[116:119], v[144:159]
    v_mfma_f32_32x32x16_bf16 v[160:175], v[244:247], v[112:115], v[160:175]
    v_mfma_f32_32x32x16_bf16 v[176:191], v[244:247], v[116:119], v[176:191]
    s_waitcnt vmcnt(20) lgkmcnt(0)
    ds_read_b64_tr_b16 v[200:201], v5 offset:2048
    ds_read_b64_tr_b16 v[202:203], v5 offset:3072
    ds_read_b64_tr_b16 v[204:205], v6 offset:2048
    ds_read_b64_tr_b16 v[206:207], v6 offset:3072
    s_add_u32 s32, s98, 20480
    buffer_load_dwordx4 v[112:115], v2, s[8:11], s32 offen offset:0 sc1
    s_add_u32 s32, s99, 20480
    buffer_load_dwordx4 v[116:119], v2, s[8:11], s32 offen offset:0 sc1
    s_add_u32 m0, s39, 0
    s_add_u32 s32, s97, 344064
    buffer_load_dwordx4 v4, s[24:27], s32 offen lds
    s_add_u32 m0, s39, 1024
    s_add_u32 s32, s97, 352256
    buffer_load_dwordx4 v4, s[24:27], s32 offen lds
    v_mfma_f32_32x32x16_bf16 v[128:143], v[192:195], v[64:67], v[128:143]
    v_mfma_f32_32x32x16_bf16 v[144:159], v[192:195], v[68:71], v[144:159]
    v_mfma_f32_32x32x16_bf16 v[160:175], v[196:199], v[64:67], v[160:175]
    v_mfma_f32_32x32x16_bf16 v[176:191], v[196:199], v[68:71], v[176:191]
    s_waitcnt vmcnt(20) lgkmcnt(0)
    ds_read_b64_tr_b16 v[208:209], v5 offset:4096
    ds_read_b64_tr_b16 v[210:211], v5 offset:5120
    ds_read_b64_tr_b16 v[212:213], v6 offset:4096
    ds_read_b64_tr_b16 v[214:215], v6 offset:5120
    s_add_u32 s32, s98, 20480
    buffer_load_dwordx4 v[64:67], v2, s[8:11], s32 offen offset:1024 sc1
    s_add_u32 s32, s99, 20480
    buffer_load_dwordx4 v[68:71], v2, s[8:11], s32 offen offset:1024 sc1
    s_add_u32 m0, s39, 2048
    s_add_u32 s32, s97, 360448
    buffer_load_dwordx4 v4, s[24:27], s32 offen lds
    s_add_u32 m0, s39, 3072
    s_add_u32 s32, s97, 368640
    buffer_load_dwordx4 v4, s[24:27], s32 offen lds
    v_mfma_f32_32x32x16_bf16 v[128:143], v[200:203], v[72:75], v[128:143]
    v_mfma_f32_32x32x16_bf16 v[144:159], v[200:203], v[76:79], v[144:159]
    v_mfma_f32_32x32x16_bf16 v[160:175], v[204:207], v[72:75], v[160:175]
    v_mfma_f32_32x32x16_bf16 v[176:191], v[204:207], v[76:79], v[176:191]
    s_waitcnt vmcnt(20) lgkmcnt(0)
    ds_read_b64_tr_b16 v[216:217], v5 offset:6144
    ds_read_b64_tr_b16 v[218:219], v5 offset:7168
    ds_read_b64_tr_b16 v[220:221], v6 offset:6144
    ds_read_b64_tr_b16 v[222:223], v6 offset:7168
    s_add_u32 s32, s98, 20480
    buffer_load_dwordx4 v[72:75], v2, s[8:11], s32 offen offset:2048 sc1
    s_add_u32 s32, s99, 20480
    buffer_load_dwordx4 v[76:79], v2, s[8:11], s32 offen offset:2048 sc1
    s_add_u32 m0, s39, 4096
    s_add_u32 s32, s97, 376832
    buffer_load_dwordx4 v4, s[24:27], s32 offen lds
    s_add_u32 m0, s39, 5120
    s_add_u32 s32, s97, 385024
    buffer_load_dwordx4 v4, s[24:27], s32 offen lds
    v_mfma_f32_32x32x16_bf16 v[128:143], v[208:211], v[80:83], v[128:143]
    v_mfma_f32_32x32x16_bf16 v[144:159], v[208:211], v[84:87], v[144:159]
    v_mfma_f32_32x32x16_bf16 v[160:175], v[212:215], v[80:83], v[160:175]
    v_mfma_f32_32x32x16_bf16 v[176:191], v[212:215], v[84:87], v[176:191]
    s_waitcnt vmcnt(20) lgkmcnt(0)
    ds_read_b64_tr_b16 v[224:225], v5 offset:8192
    ds_read_b64_tr_b16 v[226:227], v5 offset:9216
    ds_read_b64_tr_b16 v[228:229], v6 offset:8192
    ds_read_b64_tr_b16 v[230:231], v6 offset:9216
    s_add_u32 s32, s98, 20480
    buffer_load_dwordx4 v[80:83], v2, s[8:11], s32 offen offset:3072 sc1
    s_add_u32 s32, s99, 20480
    buffer_load_dwordx4 v[84:87], v2, s[8:11], s32 offen offset:3072 sc1
    s_add_u32 m0, s39, 6144
    s_add_u32 s32, s97, 393216
    buffer_load_dwordx4 v4, s[24:27], s32 offen lds
    s_add_u32 m0, s39, 7168
    s_add_u32 s32, s97, 401408
    buffer_load_dwordx4 v4, s[24:27], s32 offen lds
    v_mfma_f32_32x32x16_bf16 v[128:143], v[216:219], v[88:91], v[128:143]
    v_mfma_f32_32x32x16_bf16 v[144:159], v[216:219], v[92:95], v[144:159]
    v_mfma_f32_32x32x16_bf16 v[160:175], v[220:223], v[88:91], v[160:175]
    v_mfma_f32_32x32x16_bf16 v[176:191], v[220:223], v[92:95], v[176:191]
    s_waitcnt vmcnt(20) lgkmcnt(0)
    ds_read_b64_tr_b16 v[232:233], v5 offset:10240
    ds_read_b64_tr_b16 v[234:235], v5 offset:11264
    ds_read_b64_tr_b16 v[236:237], v6 offset:10240
    ds_read_b64_tr_b16 v[238:239], v6 offset:11264
    s_add_u32 s32, s98, 24576
    buffer_load_dwordx4 v[88:91], v2, s[8:11], s32 offen offset:0 sc1
    s_add_u32 s32, s99, 24576
    buffer_load_dwordx4 v[92:95], v2, s[8:11], s32 offen offset:0 sc1
    s_add_u32 m0, s39, 8192
    s_add_u32 s32, s97, 409600
    buffer_load_dwordx4 v4, s[24:27], s32 offen lds
    s_add_u32 m0, s39, 9216
    s_add_u32 s32, s97, 417792
    buffer_load_dwordx4 v4, s[24:27], s32 offen lds
    v_mfma_f32_32x32x16_bf16 v[128:143], v[224:227], v[96:99], v[128:143]
    v_mfma_f32_32x32x16_bf16 v[144:159], v[224:227], v[100:103], v[144:159]
    v_mfma_f32_32x32x16_bf16 v[160:175], v[228:231], v[96:99], v[160:175]
    v_mfma_f32_32x32x16_bf16 v[176:191], v[228:231], v[100:103], v[176:191]
    s_waitcnt vmcnt(20) lgkmcnt(0)
    ds_read_b64_tr_b16 v[240:241], v5 offset:12288
    ds_read_b64_tr_b16 v[242:243], v5 offset:13312
    ds_read_b64_tr_b16 v[244:245], v6 offset:12288
    ds_read_b64_tr_b16 v[246:247], v6 offset:13312
    s_add_u32 s32, s98, 24576
    buffer_load_dwordx4 v[96:99], v2, s[8:11], s32 offen offset:1024 sc1
    s_add_u32 s32, s99, 24576
    buffer_load_dwordx4 v[100:103], v2, s[8:11], s32 offen offset:1024 sc1
    s_add_u32 m0, s39, 10240
    s_add_u32 s32, s97, 425984
    buffer_load_dwordx4 v4, s[24:27], s32 offen lds
    s_add_u32 m0, s39, 11264
    s_add_u32 s32, s97, 434176
    buffer_load_dwordx4 v4, s[24:27], s32 offen lds
    v_mfma_f32_32x32x16_bf16 v[128:143], v[232:235], v[104:107], v[128:143]
    v_mfma_f32_32x32x16_bf16 v[144:159], v[232:235], v[108:111], v[144:159]
    v_mfma_f32_32x32x16_bf16 v[160:175], v[236:239], v[104:107], v[160:175]
    v_mfma_f32_32x32x16_bf16 v[176:191], v[236:239], v[108:111], v[176:191]
    s_waitcnt vmcnt(20) lgkmcnt(0)
    ds_read_b64_tr_b16 v[192:193], v5 offset:0
    ds_read_b64_tr_b16 v[194:195], v5 offset:1024
    ds_read_b64_tr_b16 v[196:197], v6 offset:0
    ds_read_b64_tr_b16 v[198:199], v6 offset:1024
    s_add_u32 s32, s98, 24576
    buffer_load_dwordx4 v[104:107], v2, s[8:11], s32 offen offset:2048 sc1
    s_add_u32 s32, s99, 24576
    buffer_load_dwordx4 v[108:111], v2, s[8:11], s32 offen offset:2048 sc1
    s_add_u32 m0, s39, 12288
    s_add_u32 s32, s97, 442368
    buffer_load_dwordx4 v4, s[24:27], s32 offen lds
    s_add_u32 m0, s39, 13312
    s_add_u32 s32, s97, 450560
    buffer_load_dwordx4 v4, s[24:27], s32 offen lds
    v_mfma_f32_32x32x16_bf16 v[128:143], v[240:243], v[112:115], v[128:143]
    v_mfma_f32_32x32x16_bf16 v[144:159], v[240:243], v[116:119], v[144:159]
    v_mfma_f32_32x32x16_bf16 v[160:175], v[244:247], v[112:115], v[160:175]
    v_mfma_f32_32x32x16_bf16 v[176:191], v[244:247], v[116:119], v[176:191]
    s_waitcnt vmcnt(20) lgkmcnt(0)
    ds_read_b64_tr_b16 v[200:201], v5 offset:2048
    ds_read_b64_tr_b16 v[202:203], v5 offset:3072
    ds_read_b64_tr_b16 v[204:205], v6 offset:2048
    ds_read_b64_tr_b16 v[206:207], v6 offset:3072
    s_add_u32 s32, s98, 24576
    buffer_load_dwordx4 v[112:115], v2, s[8:11], s32 offen offset:3072 sc1
    s_add_u32 s32, s99, 24576
    buffer_load_dwordx4 v[116:119], v2, s[8:11], s32 offen offset:3072 sc1
    v_mfma_f32_32x32x16_bf16 v[128:143], v[192:195], v[64:67], v[128:143]
    v_mfma_f32_32x32x16_bf16 v[144:159], v[192:195], v[68:71], v[144:159]
    v_mfma_f32_32x32x16_bf16 v[160:175], v[196:199], v[64:67], v[160:175]
    v_mfma_f32_32x32x16_bf16 v[176:191], v[196:199], v[68:71], v[176:191]
    s_waitcnt vmcnt(18) lgkmcnt(0)
    ds_read_b64_tr_b16 v[208:209], v5 offset:4096
    ds_read_b64_tr_b16 v[210:211], v5 offset:5120
    ds_read_b64_tr_b16 v[212:213], v6 offset:4096
    ds_read_b64_tr_b16 v[214:215], v6 offset:5120
    v_mfma_f32_32x32x16_bf16 v[128:143], v[200:203], v[72:75], v[128:143]
    v_mfma_f32_32x32x16_bf16 v[144:159], v[200:203], v[76:79], v[144:159]
    v_mfma_f32_32x32x16_bf16 v[160:175], v[204:207], v[72:75], v[160:175]
    v_mfma_f32_32x32x16_bf16 v[176:191], v[204:207], v[76:79], v[176:191]
    s_waitcnt vmcnt(14) lgkmcnt(0)
    ds_read_b64_tr_b16 v[216:217], v5 offset:6144
    ds_read_b64_tr_b16 v[218:219], v5 offset:7168
    ds_read_b64_tr_b16 v[220:221], v6 offset:6144
    ds_read_b64_tr_b16 v[222:223], v6 offset:7168
    v_mfma_f32_32x32x16_bf16 v[128:143], v[208:211], v[80:83], v[128:143]
    v_mfma_f32_32x32x16_bf16 v[144:159], v[208:211], v[84:87], v[144:159]
    v_mfma_f32_32x32x16_bf16 v[160:175], v[212:215], v[80:83], v[160:175]
    v_mfma_f32_32x32x16_bf16 v[176:191], v[212:215], v[84:87], v[176:191]
    s_waitcnt vmcnt(10) lgkmcnt(0)
    ds_read_b64_tr_b16 v[224:225], v5 offset:8192
    ds_read_b64_tr_b16 v[226:227], v5 offset:9216
    ds_read_b64_tr_b16 v[228:229], v6 offset:8192
    ds_read_b64_tr_b16 v[230:231], v6 offset:9216
    v_mfma_f32_32x32x16_bf16 v[128:143], v[216:219], v[88:91], v[128:143]
    v_mfma_f32_32x32x16_bf16 v[144:159], v[216:219], v[92:95], v[144:159]
    v_mfma_f32_32x32x16_bf16 v[160:175], v[220:223], v[88:91], v[160:175]
    v_mfma_f32_32x32x16_bf16 v[176:191], v[220:223], v[92:95], v[176:191]
    s_waitcnt vmcnt(6) lgkmcnt(0)
    ds_read_b64_tr_b16 v[232:233], v5 offset:10240
    ds_read_b64_tr_b16 v[234:235], v5 offset:11264
    ds_read_b64_tr_b16 v[236:237], v6 offset:10240
    ds_read_b64_tr_b16 v[238:239], v6 offset:11264
    v_mfma_f32_32x32x16_bf16 v[128:143], v[224:227], v[96:99], v[128:143]
    v_mfma_f32_32x32x16_bf16 v[144:159], v[224:227], v[100:103], v[144:159]
    v_mfma_f32_32x32x16_bf16 v[160:175], v[228:231], v[96:99], v[160:175]
    v_mfma_f32_32x32x16_bf16 v[176:191], v[228:231], v[100:103], v[176:191]
    s_waitcnt vmcnt(2) lgkmcnt(0)
    ds_read_b64_tr_b16 v[240:241], v5 offset:12288
    ds_read_b64_tr_b16 v[242:243], v5 offset:13312
    ds_read_b64_tr_b16 v[244:245], v6 offset:12288
    ds_read_b64_tr_b16 v[246:247], v6 offset:13312
    v_mfma_f32_32x32x16_bf16 v[128:143], v[232:235], v[104:107], v[128:143]
    v_mfma_f32_32x32x16_bf16 v[144:159], v[232:235], v[108:111], v[144:159]
    v_mfma_f32_32x32x16_bf16 v[160:175], v[236:239], v[104:107], v[160:175]
    v_mfma_f32_32x32x16_bf16 v[176:191], v[236:239], v[108:111], v[176:191]
    s_waitcnt vmcnt(0) lgkmcnt(0)
    v_mfma_f32_32x32x16_bf16 v[128:143], v[240:243], v[112:115], v[128:143]
    v_mfma_f32_32x32x16_bf16 v[144:159], v[240:243], v[116:119], v[144:159]
    v_mfma_f32_32x32x16_bf16 v[160:175], v[244:247], v[112:115], v[160:175]
    v_mfma_f32_32x32x16_bf16 v[176:191], v[244:247], v[116:119], v[176:191]
    s_setprio 0
    s_setprio 2
    v_add_u32 v11, s39, v2
    s_nop 7
    ds_write_b128 v11, v[144:147] offset:0
    ds_write_b128 v11, v[148:151] offset:1024
    ds_write_b128 v11, v[152:155] offset:2048
    ds_write_b128 v11, v[156:159] offset:3072
    ds_write_b128 v11, v[160:163] offset:4096
    ds_write_b128 v11, v[164:167] offset:5120
    ds_write_b128 v11, v[168:171] offset:6144
    ds_write_b128 v11, v[172:175] offset:7168
    ds_write_b128 v11, v[176:179] offset:8192
    ds_write_b128 v11, v[180:183] offset:9216
    ds_write_b128 v11, v[184:187] offset:10240
    ds_write_b128 v11, v[188:191] offset:11264
    v_mov_b32 v9, 106412
    v_mov_b32 v10, 1
    s_mov_b64 exec, 1
    ds_add_u32 v9, v10
    s_mov_b64 exec, -1
    s_waitcnt lgkmcnt(0)
    s_setprio 0
    v_mov_b32 v9, 106404
    s_mov_b32 s37, 65536
L_ldsw_81:
    ds_read_b32 v10, v9
    s_waitcnt lgkmcnt(0)
    v_readfirstlane_b32 s32, v10
    s_nop 3
    s_cmp_ge_u32 s32, 4
    s_cbranch_scc1 L_ldsd_82
    s_sub_u32 s37, s37, 1
    s_cmp_eq_u32 s37, 0
    s_cbranch_scc1 recurrent_scan__grouped_kv_mqa__swiglu_ffn__prompt_kernel_end
    s_sleep 1
    s_branch L_ldsw_81
L_ldsd_82:
    v_mov_b32 v9, 106380
    s_mov_b32 s37, 65536
L_ldsw_83:
    ds_read_b32 v10, v9
    s_waitcnt lgkmcnt(0)
    v_readfirstlane_b32 s32, v10
    s_nop 3
    s_cmp_ge_u32 s32, 4
    s_cbranch_scc1 L_ldsd_84
    s_sub_u32 s37, s37, 1
    s_cmp_eq_u32 s37, 0
    s_cbranch_scc1 recurrent_scan__grouped_kv_mqa__swiglu_ffn__prompt_kernel_end
    s_sleep 1
    s_branch L_ldsw_83
L_ldsd_84:
    s_lshl_b32 s32, s31, 17
    s_lshl_b32 s34, s31, 14
    s_add_u32 m0, s34, 0
    s_add_u32 s33, s32, 0
    buffer_load_dwordx4 v4, s[16:19], s33 offen lds
    s_add_u32 m0, s34, 1024
    s_add_u32 s33, s32, 8192
    buffer_load_dwordx4 v4, s[16:19], s33 offen lds
    s_add_u32 m0, s34, 2048
    s_add_u32 s33, s32, 16384
    buffer_load_dwordx4 v4, s[16:19], s33 offen lds
    s_add_u32 m0, s34, 3072
    s_add_u32 s33, s32, 24576
    buffer_load_dwordx4 v4, s[16:19], s33 offen lds
    s_add_u32 m0, s34, 4096
    s_add_u32 s33, s32, 32768
    buffer_load_dwordx4 v4, s[16:19], s33 offen lds
    s_add_u32 m0, s34, 5120
    s_add_u32 s33, s32, 40960
    buffer_load_dwordx4 v4, s[16:19], s33 offen lds
    s_add_u32 m0, s34, 6144
    s_add_u32 s33, s32, 49152
    buffer_load_dwordx4 v4, s[16:19], s33 offen lds
    s_add_u32 m0, s34, 7168
    s_add_u32 s33, s32, 57344
    buffer_load_dwordx4 v4, s[16:19], s33 offen lds
    s_add_u32 m0, s34, 8192
    s_add_u32 s33, s32, 65536
    buffer_load_dwordx4 v4, s[16:19], s33 offen lds
    s_add_u32 m0, s34, 9216
    s_add_u32 s33, s32, 73728
    buffer_load_dwordx4 v4, s[16:19], s33 offen lds
    s_add_u32 m0, s34, 10240
    s_add_u32 s33, s32, 81920
    buffer_load_dwordx4 v4, s[16:19], s33 offen lds
    s_add_u32 m0, s34, 11264
    s_add_u32 s33, s32, 90112
    buffer_load_dwordx4 v4, s[16:19], s33 offen lds
    s_add_u32 m0, s34, 12288
    s_add_u32 s33, s32, 98304
    buffer_load_dwordx4 v4, s[16:19], s33 offen lds
    s_add_u32 m0, s34, 13312
    s_add_u32 s33, s32, 106496
    buffer_load_dwordx4 v4, s[16:19], s33 offen lds
    s_add_u32 m0, s34, 14336
    s_add_u32 s33, s32, 114688
    buffer_load_dwordx4 v4, s[16:19], s33 offen lds
    s_add_u32 m0, s34, 15360
    s_add_u32 s33, s32, 122880
    buffer_load_dwordx4 v4, s[16:19], s33 offen lds
    buffer_load_dwordx2 v[160:161], v12, s[4:7], 0 offen offset:0
    buffer_load_dwordx2 v[162:163], v12, s[4:7], 0 offen offset:16
    buffer_load_dwordx2 v[164:165], v12, s[4:7], 0 offen offset:32
    buffer_load_dwordx2 v[166:167], v12, s[4:7], 0 offen offset:48
    v_mov_b32 v9, 106412
    s_mov_b32 s37, 65536
L_ldsw_85:
    ds_read_b32 v10, v9
    s_waitcnt lgkmcnt(0)
    v_readfirstlane_b32 s32, v10
    s_nop 3
    s_cmp_ge_u32 s32, 4
    s_cbranch_scc1 L_ldsd_86
    s_sub_u32 s37, s37, 1
    s_cmp_eq_u32 s37, 0
    s_cbranch_scc1 recurrent_scan__grouped_kv_mqa__swiglu_ffn__prompt_kernel_end
    s_branch L_ldsw_85
L_ldsd_86:
    s_setprio 2
    s_xor_b32 s32, s31, 1
    s_mul_i32 s32, s32, 14336
    s_add_u32 s32, s32, 106496
    v_add_u32 v11, s32, v2
    ds_read_b128 v[64:67], v11 offset:0
    ds_read_b128 v[68:71], v11 offset:1024
    ds_read_b128 v[72:75], v11 offset:2048
    ds_read_b128 v[76:79], v11 offset:3072
    s_xor_b32 s32, s31, 2
    s_mul_i32 s32, s32, 14336
    s_add_u32 s32, s32, 110592
    v_add_u32 v11, s32, v2
    ds_read_b128 v[80:83], v11 offset:0
    ds_read_b128 v[84:87], v11 offset:1024
    ds_read_b128 v[88:91], v11 offset:2048
    ds_read_b128 v[92:95], v11 offset:3072
    s_xor_b32 s32, s31, 3
    s_mul_i32 s32, s32, 14336
    s_add_u32 s32, s32, 114688
    v_add_u32 v11, s32, v2
    ds_read_b128 v[96:99], v11 offset:0
    ds_read_b128 v[100:103], v11 offset:1024
    ds_read_b128 v[104:107], v11 offset:2048
    ds_read_b128 v[108:111], v11 offset:3072
    s_waitcnt lgkmcnt(8)
    v_pk_add_f32 v[128:129], v[128:129], v[64:65]
    v_pk_add_f32 v[130:131], v[130:131], v[66:67]
    v_pk_add_f32 v[132:133], v[132:133], v[68:69]
    v_pk_add_f32 v[134:135], v[134:135], v[70:71]
    v_pk_add_f32 v[136:137], v[136:137], v[72:73]
    v_pk_add_f32 v[138:139], v[138:139], v[74:75]
    v_pk_add_f32 v[140:141], v[140:141], v[76:77]
    v_pk_add_f32 v[142:143], v[142:143], v[78:79]
    s_waitcnt lgkmcnt(4)
    v_pk_add_f32 v[128:129], v[128:129], v[80:81]
    v_pk_add_f32 v[130:131], v[130:131], v[82:83]
    v_pk_add_f32 v[132:133], v[132:133], v[84:85]
    v_pk_add_f32 v[134:135], v[134:135], v[86:87]
    v_pk_add_f32 v[136:137], v[136:137], v[88:89]
    v_pk_add_f32 v[138:139], v[138:139], v[90:91]
    v_pk_add_f32 v[140:141], v[140:141], v[92:93]
    v_pk_add_f32 v[142:143], v[142:143], v[94:95]
    s_waitcnt lgkmcnt(0)
    v_pk_add_f32 v[128:129], v[128:129], v[96:97]
    v_pk_add_f32 v[130:131], v[130:131], v[98:99]
    v_pk_add_f32 v[132:133], v[132:133], v[100:101]
    v_pk_add_f32 v[134:135], v[134:135], v[102:103]
    v_pk_add_f32 v[136:137], v[136:137], v[104:105]
    v_pk_add_f32 v[138:139], v[138:139], v[106:107]
    v_pk_add_f32 v[140:141], v[140:141], v[108:109]
    v_pk_add_f32 v[142:143], v[142:143], v[110:111]
    v_mov_b32 v9, 106424
    v_mov_b32 v10, 1
    s_mov_b64 exec, 1
    ds_add_u32 v9, v10
    s_mov_b64 exec, -1
    v_pk_mul_f32 v[64:65], v[128:129], s[44:45] op_sel_hi:[1,0]
    v_pk_mul_f32 v[66:67], v[130:131], s[44:45] op_sel_hi:[1,0]
    v_pk_mul_f32 v[68:69], v[132:133], s[44:45] op_sel_hi:[1,0]
    v_pk_mul_f32 v[70:71], v[134:135], s[44:45] op_sel_hi:[1,0]
    v_pk_mul_f32 v[72:73], v[136:137], s[44:45] op_sel_hi:[1,0]
    v_pk_mul_f32 v[74:75], v[138:139], s[44:45] op_sel_hi:[1,0]
    v_pk_mul_f32 v[76:77], v[140:141], s[44:45] op_sel_hi:[1,0]
    v_pk_mul_f32 v[78:79], v[142:143], s[44:45] op_sel_hi:[1,0]
    v_exp_f32 v64, v64
    v_exp_f32 v65, v65
    v_exp_f32 v66, v66
    v_exp_f32 v67, v67
    v_exp_f32 v68, v68
    v_exp_f32 v69, v69
    v_exp_f32 v70, v70
    v_exp_f32 v71, v71
    v_exp_f32 v72, v72
    v_exp_f32 v73, v73
    v_exp_f32 v74, v74
    v_exp_f32 v75, v75
    v_exp_f32 v76, v76
    v_exp_f32 v77, v77
    v_exp_f32 v78, v78
    v_exp_f32 v79, v79
    s_nop 0
    v_pk_add_f32 v[64:65], v[64:65], 1.0 op_sel_hi:[1,0]
    v_pk_add_f32 v[66:67], v[66:67], 1.0 op_sel_hi:[1,0]
    v_pk_add_f32 v[68:69], v[68:69], 1.0 op_sel_hi:[1,0]
    v_pk_add_f32 v[70:71], v[70:71], 1.0 op_sel_hi:[1,0]
    v_pk_add_f32 v[72:73], v[72:73], 1.0 op_sel_hi:[1,0]
    v_pk_add_f32 v[74:75], v[74:75], 1.0 op_sel_hi:[1,0]
    v_pk_add_f32 v[76:77], v[76:77], 1.0 op_sel_hi:[1,0]
    v_pk_add_f32 v[78:79], v[78:79], 1.0 op_sel_hi:[1,0]
    v_rcp_f32 v64, v64
    v_rcp_f32 v65, v65
    v_rcp_f32 v66, v66
    v_rcp_f32 v67, v67
    v_rcp_f32 v68, v68
    v_rcp_f32 v69, v69
    v_rcp_f32 v70, v70
    v_rcp_f32 v71, v71
    v_rcp_f32 v72, v72
    v_rcp_f32 v73, v73
    v_rcp_f32 v74, v74
    v_rcp_f32 v75, v75
    v_rcp_f32 v76, v76
    v_rcp_f32 v77, v77
    v_rcp_f32 v78, v78
    v_rcp_f32 v79, v79
    s_nop 0
    v_pk_mul_f32 v[128:129], v[128:129], v[64:65]
    v_pk_mul_f32 v[130:131], v[130:131], v[66:67]
    v_pk_mul_f32 v[132:133], v[132:133], v[68:69]
    v_pk_mul_f32 v[134:135], v[134:135], v[70:71]
    v_pk_mul_f32 v[136:137], v[136:137], v[72:73]
    v_pk_mul_f32 v[138:139], v[138:139], v[74:75]
    v_pk_mul_f32 v[140:141], v[140:141], v[76:77]
    v_pk_mul_f32 v[142:143], v[142:143], v[78:79]
    v_min_u32 v11, 15, v1
    v_lshlrev_b32 v11, 2, v11
    s_setprio 0
    s_mov_b32 s12, s66
    s_mov_b32 s13, s67
    s_mov_b32 s14, 0x200000
    s_mov_b32 s15, 0x00020000
    s_waitcnt vmcnt(0)
    v_mov_b32 v9, 106408
    v_mov_b32 v10, 1
    s_mov_b64 exec, 1
    ds_add_u32 v9, v10
    s_mov_b64 exec, -1
    s_lshl_b32 s34, s83, 9
    s_lshl_b32 s33, s96, 7
    s_add_u32 s34, s34, s33
    s_add_u32 s34, s34, 4391168
    s_mov_b32 s37, 65536
L_poll_87:
    buffer_load_dword v10, v11, s[8:11], s34 offen sc1
    s_waitcnt vmcnt(0)
    v_cmp_eq_u32 vcc, s38, v10
    s_nop 4
    s_cmp_eq_u64 vcc, exec
    s_cbranch_scc1 L_polld_88
    s_sub_u32 s37, s37, 1
    s_cmp_eq_u32 s37, 0
    s_cbranch_scc1 recurrent_scan__grouped_kv_mqa__swiglu_ffn__prompt_kernel_end
    s_sleep 1
    s_branch L_poll_87
L_polld_88:
    s_lshl_b32 s32, s83, 1
    s_add_u32 s32, s32, s96
    s_lshl_b32 s33, s32, 15
    s_add_u32 s33, s33, 12582912
    buffer_load_dwordx4 v[64:67], v2, s[8:11], s33 offen offset:0 sc1
    buffer_load_dwordx4 v[68:71], v2, s[8:11], s33 offen offset:1024 sc1
    buffer_load_dwordx4 v[72:75], v2, s[8:11], s33 offen offset:2048 sc1
    buffer_load_dwordx4 v[76:79], v2, s[8:11], s33 offen offset:3072 sc1
    s_add_u32 s33, s33, 4096
    buffer_load_dwordx4 v[80:83], v2, s[8:11], s33 offen offset:0 sc1
    buffer_load_dwordx4 v[84:87], v2, s[8:11], s33 offen offset:1024 sc1
    buffer_load_dwordx4 v[88:91], v2, s[8:11], s33 offen offset:2048 sc1
    buffer_load_dwordx4 v[92:95], v2, s[8:11], s33 offen offset:3072 sc1
    s_add_u32 s33, s33, 4096
    buffer_load_dwordx4 v[96:99], v2, s[8:11], s33 offen offset:0 sc1
    buffer_load_dwordx4 v[100:103], v2, s[8:11], s33 offen offset:1024 sc1
    buffer_load_dwordx4 v[104:107], v2, s[8:11], s33 offen offset:2048 sc1
    buffer_load_dwordx4 v[108:111], v2, s[8:11], s33 offen offset:3072 sc1
    s_add_u32 s33, s33, 4096
    buffer_load_dwordx4 v[112:115], v2, s[8:11], s33 offen offset:0 sc1
    buffer_load_dwordx4 v[116:119], v2, s[8:11], s33 offen offset:1024 sc1
    buffer_load_dwordx4 v[120:123], v2, s[8:11], s33 offen offset:2048 sc1
    buffer_load_dwordx4 v[124:127], v2, s[8:11], s33 offen offset:3072 sc1
    s_add_u32 s33, s33, 4096
    buffer_load_dwordx4 v[192:195], v2, s[8:11], s33 offen offset:0 sc1
    buffer_load_dwordx4 v[196:199], v2, s[8:11], s33 offen offset:1024 sc1
    buffer_load_dwordx4 v[200:203], v2, s[8:11], s33 offen offset:2048 sc1
    buffer_load_dwordx4 v[204:207], v2, s[8:11], s33 offen offset:3072 sc1
    s_add_u32 s33, s33, 4096
    buffer_load_dwordx4 v[208:211], v2, s[8:11], s33 offen offset:0 sc1
    buffer_load_dwordx4 v[212:215], v2, s[8:11], s33 offen offset:1024 sc1
    buffer_load_dwordx4 v[216:219], v2, s[8:11], s33 offen offset:2048 sc1
    buffer_load_dwordx4 v[220:223], v2, s[8:11], s33 offen offset:3072 sc1
    s_add_u32 s33, s33, 4096
    buffer_load_dwordx4 v[224:227], v2, s[8:11], s33 offen offset:0 sc1
    buffer_load_dwordx4 v[228:231], v2, s[8:11], s33 offen offset:1024 sc1
    buffer_load_dwordx4 v[232:235], v2, s[8:11], s33 offen offset:2048 sc1
    buffer_load_dwordx4 v[236:239], v2, s[8:11], s33 offen offset:3072 sc1
    s_add_u32 s33, s33, 4096
    buffer_load_dwordx4 v[240:243], v2, s[8:11], s33 offen offset:0 sc1
    buffer_load_dwordx4 v[244:247], v2, s[8:11], s33 offen offset:1024 sc1
    buffer_load_dwordx4 v[248:251], v2, s[8:11], s33 offen offset:2048 sc1
    buffer_load_dwordx4 v[252:255], v2, s[8:11], s33 offen offset:3072 sc1
    v_mov_b32 v9, 106408
    s_mov_b32 s37, 65536
L_ldsw_89:
    ds_read_b32 v10, v9
    s_waitcnt lgkmcnt(0)
    v_readfirstlane_b32 s32, v10
    s_nop 3
    s_cmp_ge_u32 s32, 4
    s_cbranch_scc1 L_ldsd_90
    s_sub_u32 s37, s37, 1
    s_cmp_eq_u32 s37, 0
    s_cbranch_scc1 recurrent_scan__grouped_kv_mqa__swiglu_ffn__prompt_kernel_end
    s_branch L_ldsw_89
L_ldsd_90:
    ds_read_b64_tr_b16 v[168:169], v7 offset:0
    ds_read_b64_tr_b16 v[170:171], v7 offset:1024
    ds_read_b64_tr_b16 v[172:173], v7 offset:2048
    ds_read_b64_tr_b16 v[174:175], v7 offset:3072
    ds_read_b64_tr_b16 v[176:177], v7 offset:4096
    ds_read_b64_tr_b16 v[178:179], v7 offset:5120
    ds_read_b64_tr_b16 v[180:181], v7 offset:6144
    ds_read_b64_tr_b16 v[182:183], v7 offset:7168
    s_waitcnt vmcnt(31) lgkmcnt(6)
    v_mfma_f32_32x32x16_bf16 v[144:159], v[168:171], v[64:67], 0
    ds_read_b64_tr_b16 v[168:169], v7 offset:8192
    ds_read_b64_tr_b16 v[170:171], v7 offset:9216
    s_waitcnt vmcnt(30) lgkmcnt(6)
    v_mfma_f32_32x32x16_bf16 v[144:159], v[172:175], v[68:71], v[144:159]
    ds_read_b64_tr_b16 v[172:173], v7 offset:10240
    ds_read_b64_tr_b16 v[174:175], v7 offset:11264
    s_waitcnt vmcnt(29) lgkmcnt(6)
    v_mfma_f32_32x32x16_bf16 v[144:159], v[176:179], v[72:75], v[144:159]
    ds_read_b64_tr_b16 v[176:177], v7 offset:12288
    ds_read_b64_tr_b16 v[178:179], v7 offset:13312
    s_waitcnt vmcnt(28) lgkmcnt(6)
    v_mfma_f32_32x32x16_bf16 v[144:159], v[180:183], v[76:79], v[144:159]
    ds_read_b64_tr_b16 v[180:181], v7 offset:14336
    ds_read_b64_tr_b16 v[182:183], v7 offset:15360
    s_waitcnt vmcnt(27) lgkmcnt(6)
    v_mfma_f32_32x32x16_bf16 v[144:159], v[168:171], v[80:83], v[144:159]
    ds_read_b64_tr_b16 v[168:169], v7 offset:16384
    ds_read_b64_tr_b16 v[170:171], v7 offset:17408
    s_waitcnt vmcnt(26) lgkmcnt(6)
    v_mfma_f32_32x32x16_bf16 v[144:159], v[172:175], v[84:87], v[144:159]
    ds_read_b64_tr_b16 v[172:173], v7 offset:18432
    ds_read_b64_tr_b16 v[174:175], v7 offset:19456
    s_waitcnt vmcnt(25) lgkmcnt(6)
    v_mfma_f32_32x32x16_bf16 v[144:159], v[176:179], v[88:91], v[144:159]
    ds_read_b64_tr_b16 v[176:177], v7 offset:20480
    ds_read_b64_tr_b16 v[178:179], v7 offset:21504
    s_waitcnt vmcnt(24) lgkmcnt(6)
    v_mfma_f32_32x32x16_bf16 v[144:159], v[180:183], v[92:95], v[144:159]
    ds_read_b64_tr_b16 v[180:181], v7 offset:22528
    ds_read_b64_tr_b16 v[182:183], v7 offset:23552
    s_waitcnt vmcnt(23) lgkmcnt(6)
    v_mfma_f32_32x32x16_bf16 v[144:159], v[168:171], v[96:99], v[144:159]
    ds_read_b64_tr_b16 v[168:169], v7 offset:24576
    ds_read_b64_tr_b16 v[170:171], v7 offset:25600
    s_waitcnt vmcnt(22) lgkmcnt(6)
    v_mfma_f32_32x32x16_bf16 v[144:159], v[172:175], v[100:103], v[144:159]
    ds_read_b64_tr_b16 v[172:173], v7 offset:26624
    ds_read_b64_tr_b16 v[174:175], v7 offset:27648
    s_waitcnt vmcnt(21) lgkmcnt(6)
    v_mfma_f32_32x32x16_bf16 v[144:159], v[176:179], v[104:107], v[144:159]
    ds_read_b64_tr_b16 v[176:177], v7 offset:28672
    ds_read_b64_tr_b16 v[178:179], v7 offset:29696
    s_waitcnt vmcnt(20) lgkmcnt(6)
    v_mfma_f32_32x32x16_bf16 v[144:159], v[180:183], v[108:111], v[144:159]
    ds_read_b64_tr_b16 v[180:181], v7 offset:30720
    ds_read_b64_tr_b16 v[182:183], v7 offset:31744
    s_waitcnt vmcnt(19) lgkmcnt(6)
    v_mfma_f32_32x32x16_bf16 v[144:159], v[168:171], v[112:115], v[144:159]
    ds_read_b64_tr_b16 v[168:169], v7 offset:32768
    ds_read_b64_tr_b16 v[170:171], v7 offset:33792
    s_waitcnt vmcnt(18) lgkmcnt(6)
    v_mfma_f32_32x32x16_bf16 v[144:159], v[172:175], v[116:119], v[144:159]
    ds_read_b64_tr_b16 v[172:173], v7 offset:34816
    ds_read_b64_tr_b16 v[174:175], v7 offset:35840
    s_waitcnt vmcnt(17) lgkmcnt(6)
    v_mfma_f32_32x32x16_bf16 v[144:159], v[176:179], v[120:123], v[144:159]
    ds_read_b64_tr_b16 v[176:177], v7 offset:36864
    ds_read_b64_tr_b16 v[178:179], v7 offset:37888
    s_waitcnt vmcnt(16) lgkmcnt(6)
    v_mfma_f32_32x32x16_bf16 v[144:159], v[180:183], v[124:127], v[144:159]
    ds_read_b64_tr_b16 v[180:181], v7 offset:38912
    ds_read_b64_tr_b16 v[182:183], v7 offset:39936
    s_waitcnt vmcnt(15) lgkmcnt(6)
    v_mfma_f32_32x32x16_bf16 v[144:159], v[168:171], v[192:195], v[144:159]
    ds_read_b64_tr_b16 v[168:169], v7 offset:40960
    ds_read_b64_tr_b16 v[170:171], v7 offset:41984
    s_waitcnt vmcnt(14) lgkmcnt(6)
    v_mfma_f32_32x32x16_bf16 v[144:159], v[172:175], v[196:199], v[144:159]
    ds_read_b64_tr_b16 v[172:173], v7 offset:43008
    ds_read_b64_tr_b16 v[174:175], v7 offset:44032
    s_waitcnt vmcnt(13) lgkmcnt(6)
    v_mfma_f32_32x32x16_bf16 v[144:159], v[176:179], v[200:203], v[144:159]
    ds_read_b64_tr_b16 v[176:177], v7 offset:45056
    ds_read_b64_tr_b16 v[178:179], v7 offset:46080
    s_waitcnt vmcnt(12) lgkmcnt(6)
    v_mfma_f32_32x32x16_bf16 v[144:159], v[180:183], v[204:207], v[144:159]
    ds_read_b64_tr_b16 v[180:181], v7 offset:47104
    ds_read_b64_tr_b16 v[182:183], v7 offset:48128
    s_waitcnt vmcnt(11) lgkmcnt(6)
    v_mfma_f32_32x32x16_bf16 v[144:159], v[168:171], v[208:211], v[144:159]
    ds_read_b64_tr_b16 v[168:169], v7 offset:49152
    ds_read_b64_tr_b16 v[170:171], v7 offset:50176
    s_waitcnt vmcnt(10) lgkmcnt(6)
    v_mfma_f32_32x32x16_bf16 v[144:159], v[172:175], v[212:215], v[144:159]
    ds_read_b64_tr_b16 v[172:173], v7 offset:51200
    ds_read_b64_tr_b16 v[174:175], v7 offset:52224
    s_waitcnt vmcnt(9) lgkmcnt(6)
    v_mfma_f32_32x32x16_bf16 v[144:159], v[176:179], v[216:219], v[144:159]
    ds_read_b64_tr_b16 v[176:177], v7 offset:53248
    ds_read_b64_tr_b16 v[178:179], v7 offset:54272
    s_waitcnt vmcnt(8) lgkmcnt(6)
    v_mfma_f32_32x32x16_bf16 v[144:159], v[180:183], v[220:223], v[144:159]
    ds_read_b64_tr_b16 v[180:181], v7 offset:55296
    ds_read_b64_tr_b16 v[182:183], v7 offset:56320
    s_waitcnt vmcnt(7) lgkmcnt(6)
    v_mfma_f32_32x32x16_bf16 v[144:159], v[168:171], v[224:227], v[144:159]
    ds_read_b64_tr_b16 v[168:169], v7 offset:57344
    ds_read_b64_tr_b16 v[170:171], v7 offset:58368
    s_waitcnt vmcnt(6) lgkmcnt(6)
    v_mfma_f32_32x32x16_bf16 v[144:159], v[172:175], v[228:231], v[144:159]
    ds_read_b64_tr_b16 v[172:173], v7 offset:59392
    ds_read_b64_tr_b16 v[174:175], v7 offset:60416
    s_waitcnt vmcnt(5) lgkmcnt(6)
    v_mfma_f32_32x32x16_bf16 v[144:159], v[176:179], v[232:235], v[144:159]
    ds_read_b64_tr_b16 v[176:177], v7 offset:61440
    ds_read_b64_tr_b16 v[178:179], v7 offset:62464
    s_waitcnt vmcnt(4) lgkmcnt(6)
    v_mfma_f32_32x32x16_bf16 v[144:159], v[180:183], v[236:239], v[144:159]
    ds_read_b64_tr_b16 v[180:181], v7 offset:63488
    ds_read_b64_tr_b16 v[182:183], v7 offset:64512
    s_waitcnt vmcnt(3) lgkmcnt(6)
    v_mfma_f32_32x32x16_bf16 v[144:159], v[168:171], v[240:243], v[144:159]
    s_waitcnt vmcnt(2) lgkmcnt(4)
    v_mfma_f32_32x32x16_bf16 v[144:159], v[172:175], v[244:247], v[144:159]
    s_waitcnt vmcnt(1) lgkmcnt(2)
    v_mfma_f32_32x32x16_bf16 v[144:159], v[176:179], v[248:251], v[144:159]
    s_waitcnt vmcnt(0) lgkmcnt(0)
    v_mfma_f32_32x32x16_bf16 v[144:159], v[180:183], v[252:255], v[144:159]
    s_setprio 2
    s_mov_b32 s47, 0xffff0000
    v_lshlrev_b32 v64, 16, v160
    v_and_b32 v65, s47, v160
    v_lshlrev_b32 v66, 16, v161
    v_and_b32 v67, s47, v161
    v_lshlrev_b32 v68, 16, v162
    v_and_b32 v69, s47, v162
    v_lshlrev_b32 v70, 16, v163
    v_and_b32 v71, s47, v163
    v_lshlrev_b32 v72, 16, v164
    v_and_b32 v73, s47, v164
    v_lshlrev_b32 v74, 16, v165
    v_and_b32 v75, s47, v165
    v_lshlrev_b32 v76, 16, v166
    v_and_b32 v77, s47, v166
    v_lshlrev_b32 v78, 16, v167
    v_and_b32 v79, s47, v167
    v_pk_fma_f32 v[64:65], v[144:145], v[128:129], v[64:65]
    v_pk_fma_f32 v[66:67], v[146:147], v[130:131], v[66:67]
    v_pk_fma_f32 v[68:69], v[148:149], v[132:133], v[68:69]
    v_pk_fma_f32 v[70:71], v[150:151], v[134:135], v[70:71]
    v_pk_fma_f32 v[72:73], v[152:153], v[136:137], v[72:73]
    v_pk_fma_f32 v[74:75], v[154:155], v[138:139], v[74:75]
    v_pk_fma_f32 v[76:77], v[156:157], v[140:141], v[76:77]
    v_pk_fma_f32 v[78:79], v[158:159], v[142:143], v[78:79]
    v_cvt_pk_bf16_f32 v160, v64, v65
    v_cvt_pk_bf16_f32 v161, v66, v67
    v_cvt_pk_bf16_f32 v162, v68, v69
    v_cvt_pk_bf16_f32 v163, v70, v71
    v_cvt_pk_bf16_f32 v164, v72, v73
    v_cvt_pk_bf16_f32 v165, v74, v75
    v_cvt_pk_bf16_f32 v166, v76, v77
    v_cvt_pk_bf16_f32 v167, v78, v79
    v_lshrrev_b32 v9, 5, v1
    v_lshlrev_b32 v9, 3, v9
    v_add_u32 v12, v12, v9
    v_permlane32_swap_b32 v160, v162
    v_permlane32_swap_b32 v161, v163
    v_permlane32_swap_b32 v164, v166
    v_permlane32_swap_b32 v165, v167
    s_nop 1
    buffer_store_dwordx4 v[160:163], v12, s[12:15], 0 offen offset:0 nt
    buffer_store_dwordx4 v[164:167], v12, s[12:15], 0 offen offset:32 nt
    s_branch recurrent_scan__grouped_kv_mqa__swiglu_ffn__prompt_kernel_end
recurrent_scan__grouped_kv_mqa__swiglu_ffn__prompt_kernel_end:
    s_endpgm
.section .rodata,"a"
.p2align 6
.amdhsa_kernel recurrent_scan__grouped_kv_mqa__swiglu_ffn__prompt_kernel
  .amdhsa_next_free_vgpr 256
  .amdhsa_next_free_sgpr 102
  .amdhsa_accum_offset 256
  .amdhsa_group_segment_fixed_size 0
  .amdhsa_kernarg_size 96
  .amdhsa_user_sgpr_count 2
  .amdhsa_user_sgpr_kernarg_segment_ptr 1
  .amdhsa_system_sgpr_workgroup_id_x 1
  .amdhsa_float_denorm_mode_32 3
.end_amdhsa_kernel
```
